```python
import torch

def _softmax(x, axis=-1):
    return torch.softmax(x, dim=axis)
def _gelu(x):
    return torch.nn.functional.gelu(x, approximate="tanh")
def _silu(x):
    return torch.nn.functional.silu(x)
def _sigmoid(x):
    return torch.sigmoid(x)
def _layernorm(x, axis=-1, eps=1e-5):
    m = x.mean(dim=axis, keepdim=True)
    v = x.var(dim=axis, keepdim=True, unbiased=False)
    return (x - m) / torch.sqrt(v + eps)
def _scatter_add(tgt, idx, src, axis=0):
    return tgt.clone().index_add_(axis, idx, src)
def _segment_sum(src, seg, n):
    out = torch.zeros((n,) + src.shape[1:], dtype=src.dtype)
    return out.index_add_(0, seg, src)
def _pad(x, pw):
    flat = tuple(v for pair in reversed(pw) for v in pair)
    return torch.nn.functional.pad(x, flat)

kernel_name = 'parallel_sum__mha_block_cached__dense_activation_silu__decode'

def setup_inputs():

    _w = (lambda a: (lambda t: t.to(torch.bfloat16) if t.is_floating_point() else t)(torch.as_tensor(a)))
    def _A_setup():
        B, Sq, D = 8, 1, 448
        H, Sk, Dh = 16, 4096, 256
        return {
            "x": _w((lambda *s: torch.randn(*s, dtype=torch.bfloat16) * 0.05)(B, Sq, D)),
            "k_cache": _w((lambda *s: torch.randn(*s, dtype=torch.bfloat16) * 3.2)(B, H, Sk, Dh)),
            "v_cache": _w((lambda *s: torch.randn(*s, dtype=torch.bfloat16) * 0.8)(B, H, Sk, Dh)),
            "wq": _w((lambda *s: torch.randn(*s, dtype=torch.bfloat16) * 3.2)(D, H * Dh) * (D ** -0.5)),
            "wo": _w((lambda *s: torch.randn(*s, dtype=torch.bfloat16) * 0.8)(H * Dh, D) * ((H * Dh) ** -0.5)),
        }
    _A_in = _A_setup()

    def _B_setup():
        B, S, D, F = 8, 1, 448, 1792
        return {
            "x": _w((lambda *s: torch.randn(*s, dtype=torch.bfloat16) * 0.05)(B, S, D)),
            "w1": _w((lambda *s: torch.randn(*s, dtype=torch.bfloat16) * 3.2)(D, F) * (D ** -0.5)),
            "w2": _w((lambda *s: torch.randn(*s, dtype=torch.bfloat16) * 0.4)(F, D) * (F ** -0.5)),
        }
    _B_in = _B_setup()

    return {
        "A_x": _A_in["x"],
        "A_k_cache": _A_in["k_cache"],
        "A_v_cache": _A_in["v_cache"],
        "A_wq": _A_in["wq"],
        "A_wo": _A_in["wo"],
        "B_x": _B_in["x"],
        "B_w1": _B_in["w1"],
        "B_w2": _B_in["w2"],
    }

def reference(A_x, A_k_cache, A_v_cache, A_wq, A_wo, B_x, B_w1, B_w2):
    def _A_ref(x, k_cache, v_cache, wq, wo):
        B, Sq, D = x.shape
        H, Dh = 16, 256
        q = (lambda x, *d: x.permute(*d))((x @ wq).reshape(B, Sq, H, Dh), 0, 2, 1, 3)
        scores = torch.einsum("bhqd,bhkd->bhqk", q, k_cache) * (Dh ** -0.5)
        p = _softmax(scores, axis=-1)
        o = torch.einsum("bhqk,bhkd->bhqd", p, v_cache)
        return (lambda x, *d: x.permute(*d))(o, 0, 2, 1, 3).reshape(B, Sq, H * Dh) @ wo

    def _B_ref(x, w1, w2):
        h = torch.einsum("bsd,df->bsf", x, w1)
        h = _silu(h)
        out = torch.einsum("bsf,fd->bsd", h, w2)
        return out

    x = A_x
    xn = _layernorm(x, axis=-1)
    return x + _A_ref(xn, A_k_cache, A_v_cache, A_wq, A_wo) + _B_ref(xn, B_w1, B_w2)
```

```asm
; @launch grid=(256,1,1) block=(512,1,1) lds=132096
.amdgcn_target "amdgcn-amd-amdhsa--gfx950"
.text
.globl parallel_sum__mha_block_cached__dense_activation_silu__decode_kernel
.p2align 8
.type parallel_sum__mha_block_cached__dense_activation_silu__decode_kernel,@function
parallel_sum__mha_block_cached__dense_activation_silu__decode_kernel:
  s_cmp_ge_u32 s2, 256
  s_cbranch_scc1 L_end
  s_memrealtime s[90:91]
  s_load_dwordx16 s[4:19], s[0:1], 0
  s_load_dwordx4 s[20:23], s[0:1], 64
  s_load_dwordx2 s[24:25], s[0:1], 80
  v_lshrrev_b32 v1, 6, v0
  v_and_b32 v0, 63, v0
  v_readfirstlane_b32 s26, v1
  v_mov_b32 v61, 0
  v_mov_b32 v62, 1
  v_mov_b32 v63, 0
  s_lshr_b32 s27, s2, 5
  s_and_b32 s30, s2, 7
  s_bfe_u32 s31, s2, 0x20003
  s_lshl_b32 s77, s30, 2
  s_add_u32 s77, s77, s31
  s_lshl_b32 s30, s30, 1
  s_and_b32 s78, s31, 1
  s_add_u32 s30, s30, s78
  s_lshr_b32 s31, s31, 1
  s_lshl_b32 s31, s31, 4
  s_add_u32 s30, s30, s31
  s_lshr_b32 s28, s30, 1
  s_cmp_ge_u32 s26, 4
  s_cbranch_scc1 L_helper
  s_lshl_b32 s31, s27, 5
  s_add_u32 s31, s31, s30
  s_lshl_b32 s31, s31, 20
  s_lshl_b32 s33, s26, 12
  v_lshlrev_b32 v1, 4, v0
  v_add_u32 v1, s33, v1
  v_lshlrev_b32 v2, 2, v0
  v_add_u32 v2, s33, v2
  v_add_u32 v2, 13312, v2
  s_mov_b32 s56, 0
  s_mov_b32 s57, 16384
  s_mov_b32 s58, 32768
  s_mov_b32 s59, 49152
  s_mov_b32 s60, 65536
  s_mov_b32 s61, 81920
  s_mov_b32 s62, 98304
  s_mov_b32 s63, 114688
  s_mov_b32 s40, 0xcccccccc
  s_mov_b32 s41, 0xcccccccc
  s_mov_b32 s42, 0xaaaaaaaa
  s_mov_b32 s43, 0xaaaaaaaa
  s_mov_b32 s46, 131072
  s_mov_b32 s47, 0x20000
  s_mov_b32 s50, 131072
  s_mov_b32 s51, 0x20000
  s_waitcnt lgkmcnt(0)
  s_add_u32 s44, s6, s31
  s_addc_u32 s45, s7, 0
  s_add_u32 s48, s44, 131072
  s_addc_u32 s49, s45, 0
  s_add_u32 s52, s8, s31
  s_addc_u32 s53, s9, 0
  buffer_load_dwordx4 v[128:131], v1, s[44:47], s56 offen offset:0 nt
  buffer_load_dwordx4 v[132:135], v1, s[44:47], s56 offen offset:1024 nt
  buffer_load_dwordx4 v[136:139], v1, s[44:47], s56 offen offset:2048 nt
  buffer_load_dwordx4 v[140:143], v1, s[44:47], s56 offen offset:3072 nt
  buffer_load_dwordx4 v[144:147], v1, s[44:47], s57 offen offset:0 nt
  buffer_load_dwordx4 v[148:151], v1, s[44:47], s57 offen offset:1024 nt
  s_cmp_lg_u32 s26, 0
  s_cbranch_scc1 L_s_nz
  v_lshlrev_b32 v3, 2, v0
  v_mov_b32 v8, 0
  v_writelane_b32 v8, s90, 7
  s_mov_b32 exec_lo, 0xffff
  s_mov_b32 exec_hi, 0
  ds_write_b32 v3, v8
  s_mov_b64 exec, -1
  s_waitcnt lgkmcnt(0)
L_s_nz:
  s_barrier
  v_mov_b32 v8, 0
  v_mov_b32 v9, 0
  v_mov_b32 v10, 0
  v_mov_b32 v11, 0
  v_mov_b32 v12, 0
  v_mov_b32 v13, 0
  v_mov_b32 v14, 0
  v_mov_b32 v15, 0
  s_waitcnt vmcnt(5)
  buffer_load_dwordx4 v[152:155], v1, s[44:47], s57 offen offset:2048 nt
  s_waitcnt vmcnt(5)
  buffer_load_dwordx4 v[156:159], v1, s[44:47], s57 offen offset:3072 nt
  s_waitcnt vmcnt(5)
  buffer_load_dwordx4 v[160:163], v1, s[44:47], s58 offen offset:0 nt
  s_waitcnt vmcnt(5)
  buffer_load_dwordx4 v[164:167], v1, s[44:47], s58 offen offset:1024 nt
  s_waitcnt vmcnt(5)
  buffer_load_dwordx4 v[168:171], v1, s[44:47], s58 offen offset:2048 nt
  s_waitcnt vmcnt(5)
  buffer_load_dwordx4 v[172:175], v1, s[44:47], s58 offen offset:3072 nt
  s_waitcnt vmcnt(5)
  buffer_load_dwordx4 v[176:179], v1, s[44:47], s59 offen offset:0 nt
  s_waitcnt vmcnt(5)
  buffer_load_dwordx4 v[180:183], v1, s[44:47], s59 offen offset:1024 nt
  s_waitcnt vmcnt(5)
  buffer_load_dwordx4 v[184:187], v1, s[44:47], s59 offen offset:2048 nt
  s_waitcnt vmcnt(5)
  buffer_load_dwordx4 v[188:191], v1, s[44:47], s59 offen offset:3072 nt
  s_waitcnt vmcnt(5)
  buffer_load_dwordx4 v[64:67], v1, s[44:47], s60 offen offset:0 nt
  s_waitcnt vmcnt(5)
  buffer_load_dwordx4 v[68:71], v1, s[44:47], s60 offen offset:1024 nt
  s_waitcnt vmcnt(5)
  buffer_load_dwordx4 v[72:75], v1, s[44:47], s60 offen offset:2048 nt
  s_waitcnt vmcnt(5)
  buffer_load_dwordx4 v[76:79], v1, s[44:47], s60 offen offset:3072 nt
  s_waitcnt vmcnt(5)
  buffer_load_dwordx4 v[80:83], v1, s[44:47], s61 offen offset:0 nt
  s_waitcnt vmcnt(5)
  buffer_load_dwordx4 v[84:87], v1, s[44:47], s61 offen offset:1024 nt
  s_waitcnt vmcnt(5)
  buffer_load_dwordx4 v[88:91], v1, s[44:47], s61 offen offset:2048 nt
  s_waitcnt vmcnt(5)
  buffer_load_dwordx4 v[92:95], v1, s[44:47], s61 offen offset:3072 nt
  s_waitcnt vmcnt(5)
  buffer_load_dwordx4 v[96:99], v1, s[44:47], s62 offen offset:0 nt
  s_waitcnt vmcnt(5)
  buffer_load_dwordx4 v[100:103], v1, s[44:47], s62 offen offset:1024 nt
  s_waitcnt vmcnt(5)
  buffer_load_dwordx4 v[104:107], v1, s[44:47], s62 offen offset:2048 nt
  s_waitcnt vmcnt(5)
  buffer_load_dwordx4 v[108:111], v1, s[44:47], s62 offen offset:3072 nt
  s_waitcnt vmcnt(5)
  buffer_load_dwordx4 v[112:115], v1, s[44:47], s63 offen offset:0 nt
  s_waitcnt vmcnt(5)
  buffer_load_dwordx4 v[116:119], v1, s[44:47], s63 offen offset:1024 nt
  s_waitcnt vmcnt(5)
  buffer_load_dwordx4 v[120:123], v1, s[44:47], s63 offen offset:2048 nt
  s_waitcnt vmcnt(5)
  buffer_load_dwordx4 v[124:127], v1, s[44:47], s63 offen offset:3072 nt
  s_waitcnt vmcnt(5)
  buffer_load_dwordx4 v[192:195], v1, s[48:51], s56 offen offset:0 nt
  s_waitcnt vmcnt(5)
  buffer_load_dwordx4 v[196:199], v1, s[48:51], s56 offen offset:1024 nt
  s_waitcnt vmcnt(5)
  buffer_load_dwordx4 v[200:203], v1, s[48:51], s56 offen offset:2048 nt
  s_waitcnt vmcnt(5)
  buffer_load_dwordx4 v[204:207], v1, s[48:51], s56 offen offset:3072 nt
  s_waitcnt vmcnt(5)
  buffer_load_dwordx4 v[208:211], v1, s[48:51], s57 offen offset:0 nt
  s_waitcnt vmcnt(5)
  buffer_load_dwordx4 v[212:215], v1, s[48:51], s57 offen offset:1024 nt
  s_waitcnt vmcnt(5)
  buffer_load_dwordx4 v[216:219], v1, s[48:51], s57 offen offset:2048 nt
  s_waitcnt vmcnt(5)
  buffer_load_dwordx4 v[220:223], v1, s[48:51], s57 offen offset:3072 nt
  s_waitcnt vmcnt(5)
  buffer_load_dwordx4 v[224:227], v1, s[48:51], s58 offen offset:0 nt
  s_waitcnt vmcnt(5)
  buffer_load_dwordx4 v[228:231], v1, s[48:51], s58 offen offset:1024 nt
  s_waitcnt vmcnt(5)
  buffer_load_dwordx4 v[232:235], v1, s[48:51], s58 offen offset:2048 nt
  s_waitcnt vmcnt(5)
  buffer_load_dwordx4 v[236:239], v1, s[48:51], s58 offen offset:3072 nt
  s_waitcnt vmcnt(5)
  buffer_load_dwordx4 v[240:243], v1, s[48:51], s59 offen offset:0 nt
  s_waitcnt vmcnt(5)
  buffer_load_dwordx4 v[244:247], v1, s[48:51], s59 offen offset:1024 nt
  s_waitcnt vmcnt(5)
  buffer_load_dwordx4 v[248:251], v1, s[48:51], s59 offen offset:2048 nt
  s_waitcnt vmcnt(5)
  buffer_load_dwordx4 v[252:255], v1, s[48:51], s59 offen offset:3072 nt
L_poll_1:
  ds_read_b32 v3, v61 offset:4
  s_waitcnt lgkmcnt(0)
  v_readfirstlane_b32 s36, v3
  s_cmp_eq_u32 s36, 1
  s_cbranch_scc1 L_pd_2
  s_sleep 1
  s_branch L_poll_1
L_pd_2:
  v_and_b32 v3, 31, v0
  v_lshlrev_b32 v3, 4, v3
  ds_read_b128 v[4:7], v3 offset:256
  s_waitcnt lgkmcnt(0)
  s_waitcnt vmcnt(5)
  v_mov_b32 v16, 0
  v_dot2c_f32_bf16 v16, v128, v4
  v_dot2c_f32_bf16 v16, v129, v5
  v_dot2c_f32_bf16 v16, v130, v6
  v_dot2c_f32_bf16 v16, v131, v7
  v_mov_b32 v17, 0
  v_dot2c_f32_bf16 v17, v132, v4
  v_dot2c_f32_bf16 v17, v133, v5
  v_dot2c_f32_bf16 v17, v134, v6
  v_dot2c_f32_bf16 v17, v135, v7
  buffer_load_dwordx4 v[128:131], v1, s[48:51], s60 offen offset:0 nt
  s_waitcnt vmcnt(5)
  buffer_load_dwordx4 v[132:135], v1, s[48:51], s60 offen offset:1024 nt
  v_mov_b32 v18, 0
  v_dot2c_f32_bf16 v18, v136, v4
  v_dot2c_f32_bf16 v18, v137, v5
  v_dot2c_f32_bf16 v18, v138, v6
  v_dot2c_f32_bf16 v18, v139, v7
  v_mov_b32 v19, 0
  v_dot2c_f32_bf16 v19, v140, v4
  v_dot2c_f32_bf16 v19, v141, v5
  v_dot2c_f32_bf16 v19, v142, v6
  v_dot2c_f32_bf16 v19, v143, v7
  s_waitcnt vmcnt(5)
  buffer_load_dwordx4 v[136:139], v1, s[48:51], s60 offen offset:2048 nt
  v_mov_b32 v20, 0
  v_dot2c_f32_bf16 v20, v144, v4
  v_dot2c_f32_bf16 v20, v145, v5
  v_dot2c_f32_bf16 v20, v146, v6
  v_dot2c_f32_bf16 v20, v147, v7
  v_mov_b32 v21, 0
  v_dot2c_f32_bf16 v21, v148, v4
  v_dot2c_f32_bf16 v21, v149, v5
  v_dot2c_f32_bf16 v21, v150, v6
  v_dot2c_f32_bf16 v21, v151, v7
  s_waitcnt vmcnt(5)
  buffer_load_dwordx4 v[140:143], v1, s[48:51], s60 offen offset:3072 nt
  v_mov_b32 v22, 0
  v_dot2c_f32_bf16 v22, v152, v4
  v_dot2c_f32_bf16 v22, v153, v5
  v_dot2c_f32_bf16 v22, v154, v6
  v_dot2c_f32_bf16 v22, v155, v7
  v_mov_b32 v23, 0
  v_dot2c_f32_bf16 v23, v156, v4
  v_dot2c_f32_bf16 v23, v157, v5
  v_dot2c_f32_bf16 v23, v158, v6
  v_dot2c_f32_bf16 v23, v159, v7
  s_waitcnt vmcnt(5)
  buffer_load_dwordx4 v[144:147], v1, s[48:51], s61 offen offset:0 nt
  v_mov_b32 v24, 0
  v_dot2c_f32_bf16 v24, v160, v4
  v_dot2c_f32_bf16 v24, v161, v5
  v_dot2c_f32_bf16 v24, v162, v6
  v_dot2c_f32_bf16 v24, v163, v7
  v_mov_b32 v25, 0
  v_dot2c_f32_bf16 v25, v164, v4
  v_dot2c_f32_bf16 v25, v165, v5
  v_dot2c_f32_bf16 v25, v166, v6
  v_dot2c_f32_bf16 v25, v167, v7
  s_waitcnt vmcnt(5)
  buffer_load_dwordx4 v[148:151], v1, s[48:51], s61 offen offset:1024 nt
  v_mov_b32 v26, 0
  v_dot2c_f32_bf16 v26, v168, v4
  v_dot2c_f32_bf16 v26, v169, v5
  v_dot2c_f32_bf16 v26, v170, v6
  v_dot2c_f32_bf16 v26, v171, v7
  v_mov_b32 v27, 0
  v_dot2c_f32_bf16 v27, v172, v4
  v_dot2c_f32_bf16 v27, v173, v5
  v_dot2c_f32_bf16 v27, v174, v6
  v_dot2c_f32_bf16 v27, v175, v7
  s_waitcnt vmcnt(5)
  buffer_load_dwordx4 v[152:155], v1, s[48:51], s61 offen offset:2048 nt
  v_mov_b32 v28, 0
  v_dot2c_f32_bf16 v28, v176, v4
  v_dot2c_f32_bf16 v28, v177, v5
  v_dot2c_f32_bf16 v28, v178, v6
  v_dot2c_f32_bf16 v28, v179, v7
  v_mov_b32 v29, 0
  v_dot2c_f32_bf16 v29, v180, v4
  v_dot2c_f32_bf16 v29, v181, v5
  v_dot2c_f32_bf16 v29, v182, v6
  v_dot2c_f32_bf16 v29, v183, v7
  s_waitcnt vmcnt(5)
  buffer_load_dwordx4 v[156:159], v1, s[48:51], s61 offen offset:3072 nt
  v_mov_b32 v30, 0
  v_dot2c_f32_bf16 v30, v184, v4
  v_dot2c_f32_bf16 v30, v185, v5
  v_dot2c_f32_bf16 v30, v186, v6
  v_dot2c_f32_bf16 v30, v187, v7
  v_mov_b32 v31, 0
  v_dot2c_f32_bf16 v31, v188, v4
  v_dot2c_f32_bf16 v31, v189, v5
  v_dot2c_f32_bf16 v31, v190, v6
  v_dot2c_f32_bf16 v31, v191, v7
  v_add_f32_dpp v16, v16, v16 row_ror:8 row_mask:0xf bank_mask:0x3
  v_add_f32_dpp v17, v17, v17 row_ror:8 row_mask:0xf bank_mask:0x3
  v_add_f32_dpp v18, v18, v18 row_ror:8 row_mask:0xf bank_mask:0x3
  v_add_f32_dpp v19, v19, v19 row_ror:8 row_mask:0xf bank_mask:0x3
  v_add_f32_dpp v20, v20, v20 row_ror:8 row_mask:0xf bank_mask:0x3
  v_add_f32_dpp v21, v21, v21 row_ror:8 row_mask:0xf bank_mask:0x3
  v_add_f32_dpp v22, v22, v22 row_ror:8 row_mask:0xf bank_mask:0x3
  v_add_f32_dpp v23, v23, v23 row_ror:8 row_mask:0xf bank_mask:0x3
  v_add_f32_dpp v16, v24, v24 row_ror:8 row_mask:0xf bank_mask:0xc
  v_add_f32_dpp v17, v25, v25 row_ror:8 row_mask:0xf bank_mask:0xc
  v_add_f32_dpp v18, v26, v26 row_ror:8 row_mask:0xf bank_mask:0xc
  v_add_f32_dpp v19, v27, v27 row_ror:8 row_mask:0xf bank_mask:0xc
  v_add_f32_dpp v20, v28, v28 row_ror:8 row_mask:0xf bank_mask:0xc
  v_add_f32_dpp v21, v29, v29 row_ror:8 row_mask:0xf bank_mask:0xc
  v_add_f32_dpp v22, v30, v30 row_ror:8 row_mask:0xf bank_mask:0xc
  v_add_f32_dpp v23, v31, v31 row_ror:8 row_mask:0xf bank_mask:0xc
  v_add_f32_dpp v24, v16, v16 row_half_mirror row_mask:0xf bank_mask:0x5
  v_add_f32_dpp v25, v17, v17 row_half_mirror row_mask:0xf bank_mask:0x5
  v_add_f32_dpp v26, v18, v18 row_half_mirror row_mask:0xf bank_mask:0x5
  v_add_f32_dpp v27, v19, v19 row_half_mirror row_mask:0xf bank_mask:0x5
  v_add_f32_dpp v24, v20, v20 row_half_mirror row_mask:0xf bank_mask:0xa
  v_add_f32_dpp v25, v21, v21 row_half_mirror row_mask:0xf bank_mask:0xa
  v_add_f32_dpp v26, v22, v22 row_half_mirror row_mask:0xf bank_mask:0xa
  v_add_f32_dpp v27, v23, v23 row_half_mirror row_mask:0xf bank_mask:0xa
  v_add_f32_dpp v24, v24, v24 quad_perm:[2,3,0,1] row_mask:0xf bank_mask:0xf
  v_add_f32_dpp v25, v25, v25 quad_perm:[2,3,0,1] row_mask:0xf bank_mask:0xf
  v_add_f32_dpp v26, v26, v26 quad_perm:[2,3,0,1] row_mask:0xf bank_mask:0xf
  v_add_f32_dpp v27, v27, v27 quad_perm:[2,3,0,1] row_mask:0xf bank_mask:0xf
  v_cndmask_b32 v16, v24, v26, s[40:41]
  v_cndmask_b32 v17, v25, v27, s[40:41]
  s_nop 0
  v_add_f32_dpp v16, v16, v16 quad_perm:[1,0,3,2] row_mask:0xf bank_mask:0xf
  v_add_f32_dpp v17, v17, v17 quad_perm:[1,0,3,2] row_mask:0xf bank_mask:0xf
  v_cndmask_b32 v16, v16, v17, s[42:43]
  v_mov_b32 v17, v16
  s_nop 1
  v_permlane16_swap_b32 v16, v17
  v_add_f32 v3, v16, v17
  ds_write_b32 v2, v3 offset:0
  s_waitcnt vmcnt(5)
  buffer_load_dwordx4 v[160:163], v1, s[48:51], s62 offen offset:0 nt
  v_mov_b32 v16, 0
  v_dot2c_f32_bf16 v16, v64, v4
  v_dot2c_f32_bf16 v16, v65, v5
  v_dot2c_f32_bf16 v16, v66, v6
  v_dot2c_f32_bf16 v16, v67, v7
  v_mov_b32 v17, 0
  v_dot2c_f32_bf16 v17, v68, v4
  v_dot2c_f32_bf16 v17, v69, v5
  v_dot2c_f32_bf16 v17, v70, v6
  v_dot2c_f32_bf16 v17, v71, v7
  s_waitcnt vmcnt(5)
  buffer_load_dwordx4 v[164:167], v1, s[48:51], s62 offen offset:1024 nt
  v_mov_b32 v18, 0
  v_dot2c_f32_bf16 v18, v72, v4
  v_dot2c_f32_bf16 v18, v73, v5
  v_dot2c_f32_bf16 v18, v74, v6
  v_dot2c_f32_bf16 v18, v75, v7
  v_mov_b32 v19, 0
  v_dot2c_f32_bf16 v19, v76, v4
  v_dot2c_f32_bf16 v19, v77, v5
  v_dot2c_f32_bf16 v19, v78, v6
  v_dot2c_f32_bf16 v19, v79, v7
  s_waitcnt vmcnt(5)
  buffer_load_dwordx4 v[168:171], v1, s[48:51], s62 offen offset:2048 nt
  v_mov_b32 v20, 0
  v_dot2c_f32_bf16 v20, v80, v4
  v_dot2c_f32_bf16 v20, v81, v5
  v_dot2c_f32_bf16 v20, v82, v6
  v_dot2c_f32_bf16 v20, v83, v7
  v_mov_b32 v21, 0
  v_dot2c_f32_bf16 v21, v84, v4
  v_dot2c_f32_bf16 v21, v85, v5
  v_dot2c_f32_bf16 v21, v86, v6
  v_dot2c_f32_bf16 v21, v87, v7
  s_waitcnt vmcnt(5)
  buffer_load_dwordx4 v[172:175], v1, s[48:51], s62 offen offset:3072 nt
  v_mov_b32 v22, 0
  v_dot2c_f32_bf16 v22, v88, v4
  v_dot2c_f32_bf16 v22, v89, v5
  v_dot2c_f32_bf16 v22, v90, v6
  v_dot2c_f32_bf16 v22, v91, v7
  v_mov_b32 v23, 0
  v_dot2c_f32_bf16 v23, v92, v4
  v_dot2c_f32_bf16 v23, v93, v5
  v_dot2c_f32_bf16 v23, v94, v6
  v_dot2c_f32_bf16 v23, v95, v7
  s_waitcnt vmcnt(5)
  buffer_load_dwordx4 v[176:179], v1, s[48:51], s63 offen offset:0 nt
  v_mov_b32 v24, 0
  v_dot2c_f32_bf16 v24, v96, v4
  v_dot2c_f32_bf16 v24, v97, v5
  v_dot2c_f32_bf16 v24, v98, v6
  v_dot2c_f32_bf16 v24, v99, v7
  v_mov_b32 v25, 0
  v_dot2c_f32_bf16 v25, v100, v4
  v_dot2c_f32_bf16 v25, v101, v5
  v_dot2c_f32_bf16 v25, v102, v6
  v_dot2c_f32_bf16 v25, v103, v7
  s_waitcnt vmcnt(5)
  buffer_load_dwordx4 v[180:183], v1, s[48:51], s63 offen offset:1024 nt
  v_mov_b32 v26, 0
  v_dot2c_f32_bf16 v26, v104, v4
  v_dot2c_f32_bf16 v26, v105, v5
  v_dot2c_f32_bf16 v26, v106, v6
  v_dot2c_f32_bf16 v26, v107, v7
  v_mov_b32 v27, 0
  v_dot2c_f32_bf16 v27, v108, v4
  v_dot2c_f32_bf16 v27, v109, v5
  v_dot2c_f32_bf16 v27, v110, v6
  v_dot2c_f32_bf16 v27, v111, v7
  s_waitcnt vmcnt(5)
  buffer_load_dwordx4 v[184:187], v1, s[48:51], s63 offen offset:2048 nt
  v_mov_b32 v28, 0
  v_dot2c_f32_bf16 v28, v112, v4
  v_dot2c_f32_bf16 v28, v113, v5
  v_dot2c_f32_bf16 v28, v114, v6
  v_dot2c_f32_bf16 v28, v115, v7
  v_mov_b32 v29, 0
  v_dot2c_f32_bf16 v29, v116, v4
  v_dot2c_f32_bf16 v29, v117, v5
  v_dot2c_f32_bf16 v29, v118, v6
  v_dot2c_f32_bf16 v29, v119, v7
  s_waitcnt vmcnt(5)
  buffer_load_dwordx4 v[188:191], v1, s[48:51], s63 offen offset:3072 nt
  v_mov_b32 v30, 0
  v_dot2c_f32_bf16 v30, v120, v4
  v_dot2c_f32_bf16 v30, v121, v5
  v_dot2c_f32_bf16 v30, v122, v6
  v_dot2c_f32_bf16 v30, v123, v7
  v_mov_b32 v31, 0
  v_dot2c_f32_bf16 v31, v124, v4
  v_dot2c_f32_bf16 v31, v125, v5
  v_dot2c_f32_bf16 v31, v126, v6
  v_dot2c_f32_bf16 v31, v127, v7
  v_add_f32_dpp v16, v16, v16 row_ror:8 row_mask:0xf bank_mask:0x3
  v_add_f32_dpp v17, v17, v17 row_ror:8 row_mask:0xf bank_mask:0x3
  v_add_f32_dpp v18, v18, v18 row_ror:8 row_mask:0xf bank_mask:0x3
  v_add_f32_dpp v19, v19, v19 row_ror:8 row_mask:0xf bank_mask:0x3
  v_add_f32_dpp v20, v20, v20 row_ror:8 row_mask:0xf bank_mask:0x3
  v_add_f32_dpp v21, v21, v21 row_ror:8 row_mask:0xf bank_mask:0x3
  v_add_f32_dpp v22, v22, v22 row_ror:8 row_mask:0xf bank_mask:0x3
  v_add_f32_dpp v23, v23, v23 row_ror:8 row_mask:0xf bank_mask:0x3
  v_add_f32_dpp v16, v24, v24 row_ror:8 row_mask:0xf bank_mask:0xc
  v_add_f32_dpp v17, v25, v25 row_ror:8 row_mask:0xf bank_mask:0xc
  v_add_f32_dpp v18, v26, v26 row_ror:8 row_mask:0xf bank_mask:0xc
  v_add_f32_dpp v19, v27, v27 row_ror:8 row_mask:0xf bank_mask:0xc
  v_add_f32_dpp v20, v28, v28 row_ror:8 row_mask:0xf bank_mask:0xc
  v_add_f32_dpp v21, v29, v29 row_ror:8 row_mask:0xf bank_mask:0xc
  v_add_f32_dpp v22, v30, v30 row_ror:8 row_mask:0xf bank_mask:0xc
  v_add_f32_dpp v23, v31, v31 row_ror:8 row_mask:0xf bank_mask:0xc
  v_add_f32_dpp v24, v16, v16 row_half_mirror row_mask:0xf bank_mask:0x5
  v_add_f32_dpp v25, v17, v17 row_half_mirror row_mask:0xf bank_mask:0x5
  v_add_f32_dpp v26, v18, v18 row_half_mirror row_mask:0xf bank_mask:0x5
  v_add_f32_dpp v27, v19, v19 row_half_mirror row_mask:0xf bank_mask:0x5
  v_add_f32_dpp v24, v20, v20 row_half_mirror row_mask:0xf bank_mask:0xa
  v_add_f32_dpp v25, v21, v21 row_half_mirror row_mask:0xf bank_mask:0xa
  v_add_f32_dpp v26, v22, v22 row_half_mirror row_mask:0xf bank_mask:0xa
  v_add_f32_dpp v27, v23, v23 row_half_mirror row_mask:0xf bank_mask:0xa
  v_add_f32_dpp v24, v24, v24 quad_perm:[2,3,0,1] row_mask:0xf bank_mask:0xf
  v_add_f32_dpp v25, v25, v25 quad_perm:[2,3,0,1] row_mask:0xf bank_mask:0xf
  v_add_f32_dpp v26, v26, v26 quad_perm:[2,3,0,1] row_mask:0xf bank_mask:0xf
  v_add_f32_dpp v27, v27, v27 quad_perm:[2,3,0,1] row_mask:0xf bank_mask:0xf
  v_cndmask_b32 v16, v24, v26, s[40:41]
  v_cndmask_b32 v17, v25, v27, s[40:41]
  s_nop 0
  v_add_f32_dpp v16, v16, v16 quad_perm:[1,0,3,2] row_mask:0xf bank_mask:0xf
  v_add_f32_dpp v17, v17, v17 quad_perm:[1,0,3,2] row_mask:0xf bank_mask:0xf
  v_cndmask_b32 v16, v16, v17, s[42:43]
  v_mov_b32 v17, v16
  s_nop 1
  v_permlane16_swap_b32 v16, v17
  v_add_f32 v3, v16, v17
  ds_write_b32 v2, v3 offset:256
  s_waitcnt vmcnt(5)
  s_mov_b32 s44, s48
  s_mov_b32 s45, s49
  s_add_u32 s48, s48, 131072
  s_addc_u32 s49, s49, 0
  buffer_load_dwordx4 v[64:67], v1, s[48:51], s56 offen offset:0 nt
  v_mov_b32 v16, 0
  v_dot2c_f32_bf16 v16, v192, v4
  v_dot2c_f32_bf16 v16, v193, v5
  v_dot2c_f32_bf16 v16, v194, v6
  v_dot2c_f32_bf16 v16, v195, v7
  v_mov_b32 v17, 0
  v_dot2c_f32_bf16 v17, v196, v4
  v_dot2c_f32_bf16 v17, v197, v5
  v_dot2c_f32_bf16 v17, v198, v6
  v_dot2c_f32_bf16 v17, v199, v7
  s_waitcnt vmcnt(5)
  buffer_load_dwordx4 v[68:71], v1, s[48:51], s56 offen offset:1024 nt
  v_mov_b32 v18, 0
  v_dot2c_f32_bf16 v18, v200, v4
  v_dot2c_f32_bf16 v18, v201, v5
  v_dot2c_f32_bf16 v18, v202, v6
  v_dot2c_f32_bf16 v18, v203, v7
  v_mov_b32 v19, 0
  v_dot2c_f32_bf16 v19, v204, v4
  v_dot2c_f32_bf16 v19, v205, v5
  v_dot2c_f32_bf16 v19, v206, v6
  v_dot2c_f32_bf16 v19, v207, v7
  s_waitcnt vmcnt(5)
  buffer_load_dwordx4 v[72:75], v1, s[48:51], s56 offen offset:2048 nt
  v_mov_b32 v20, 0
  v_dot2c_f32_bf16 v20, v208, v4
  v_dot2c_f32_bf16 v20, v209, v5
  v_dot2c_f32_bf16 v20, v210, v6
  v_dot2c_f32_bf16 v20, v211, v7
  v_mov_b32 v21, 0
  v_dot2c_f32_bf16 v21, v212, v4
  v_dot2c_f32_bf16 v21, v213, v5
  v_dot2c_f32_bf16 v21, v214, v6
  v_dot2c_f32_bf16 v21, v215, v7
  s_waitcnt vmcnt(5)
  buffer_load_dwordx4 v[76:79], v1, s[48:51], s56 offen offset:3072 nt
  v_mov_b32 v22, 0
  v_dot2c_f32_bf16 v22, v216, v4
  v_dot2c_f32_bf16 v22, v217, v5
  v_dot2c_f32_bf16 v22, v218, v6
  v_dot2c_f32_bf16 v22, v219, v7
  v_mov_b32 v23, 0
  v_dot2c_f32_bf16 v23, v220, v4
  v_dot2c_f32_bf16 v23, v221, v5
  v_dot2c_f32_bf16 v23, v222, v6
  v_dot2c_f32_bf16 v23, v223, v7
  s_waitcnt vmcnt(5)
  buffer_load_dwordx4 v[80:83], v1, s[48:51], s57 offen offset:0 nt
  v_mov_b32 v24, 0
  v_dot2c_f32_bf16 v24, v224, v4
  v_dot2c_f32_bf16 v24, v225, v5
  v_dot2c_f32_bf16 v24, v226, v6
  v_dot2c_f32_bf16 v24, v227, v7
  v_mov_b32 v25, 0
  v_dot2c_f32_bf16 v25, v228, v4
  v_dot2c_f32_bf16 v25, v229, v5
  v_dot2c_f32_bf16 v25, v230, v6
  v_dot2c_f32_bf16 v25, v231, v7
  s_waitcnt vmcnt(5)
  buffer_load_dwordx4 v[84:87], v1, s[48:51], s57 offen offset:1024 nt
  v_mov_b32 v26, 0
  v_dot2c_f32_bf16 v26, v232, v4
  v_dot2c_f32_bf16 v26, v233, v5
  v_dot2c_f32_bf16 v26, v234, v6
  v_dot2c_f32_bf16 v26, v235, v7
  v_mov_b32 v27, 0
  v_dot2c_f32_bf16 v27, v236, v4
  v_dot2c_f32_bf16 v27, v237, v5
  v_dot2c_f32_bf16 v27, v238, v6
  v_dot2c_f32_bf16 v27, v239, v7
  s_waitcnt vmcnt(5)
  buffer_load_dwordx4 v[88:91], v1, s[48:51], s57 offen offset:2048 nt
  v_mov_b32 v28, 0
  v_dot2c_f32_bf16 v28, v240, v4
  v_dot2c_f32_bf16 v28, v241, v5
  v_dot2c_f32_bf16 v28, v242, v6
  v_dot2c_f32_bf16 v28, v243, v7
  v_mov_b32 v29, 0
  v_dot2c_f32_bf16 v29, v244, v4
  v_dot2c_f32_bf16 v29, v245, v5
  v_dot2c_f32_bf16 v29, v246, v6
  v_dot2c_f32_bf16 v29, v247, v7
  s_waitcnt vmcnt(5)
  buffer_load_dwordx4 v[92:95], v1, s[48:51], s57 offen offset:3072 nt
  v_mov_b32 v30, 0
  v_dot2c_f32_bf16 v30, v248, v4
  v_dot2c_f32_bf16 v30, v249, v5
  v_dot2c_f32_bf16 v30, v250, v6
  v_dot2c_f32_bf16 v30, v251, v7
  v_mov_b32 v31, 0
  v_dot2c_f32_bf16 v31, v252, v4
  v_dot2c_f32_bf16 v31, v253, v5
  v_dot2c_f32_bf16 v31, v254, v6
  v_dot2c_f32_bf16 v31, v255, v7
  v_add_f32_dpp v16, v16, v16 row_ror:8 row_mask:0xf bank_mask:0x3
  v_add_f32_dpp v17, v17, v17 row_ror:8 row_mask:0xf bank_mask:0x3
  v_add_f32_dpp v18, v18, v18 row_ror:8 row_mask:0xf bank_mask:0x3
  v_add_f32_dpp v19, v19, v19 row_ror:8 row_mask:0xf bank_mask:0x3
  v_add_f32_dpp v20, v20, v20 row_ror:8 row_mask:0xf bank_mask:0x3
  v_add_f32_dpp v21, v21, v21 row_ror:8 row_mask:0xf bank_mask:0x3
  v_add_f32_dpp v22, v22, v22 row_ror:8 row_mask:0xf bank_mask:0x3
  v_add_f32_dpp v23, v23, v23 row_ror:8 row_mask:0xf bank_mask:0x3
  v_add_f32_dpp v16, v24, v24 row_ror:8 row_mask:0xf bank_mask:0xc
  v_add_f32_dpp v17, v25, v25 row_ror:8 row_mask:0xf bank_mask:0xc
  v_add_f32_dpp v18, v26, v26 row_ror:8 row_mask:0xf bank_mask:0xc
  v_add_f32_dpp v19, v27, v27 row_ror:8 row_mask:0xf bank_mask:0xc
  v_add_f32_dpp v20, v28, v28 row_ror:8 row_mask:0xf bank_mask:0xc
  v_add_f32_dpp v21, v29, v29 row_ror:8 row_mask:0xf bank_mask:0xc
  v_add_f32_dpp v22, v30, v30 row_ror:8 row_mask:0xf bank_mask:0xc
  v_add_f32_dpp v23, v31, v31 row_ror:8 row_mask:0xf bank_mask:0xc
  v_add_f32_dpp v24, v16, v16 row_half_mirror row_mask:0xf bank_mask:0x5
  v_add_f32_dpp v25, v17, v17 row_half_mirror row_mask:0xf bank_mask:0x5
  v_add_f32_dpp v26, v18, v18 row_half_mirror row_mask:0xf bank_mask:0x5
  v_add_f32_dpp v27, v19, v19 row_half_mirror row_mask:0xf bank_mask:0x5
  v_add_f32_dpp v24, v20, v20 row_half_mirror row_mask:0xf bank_mask:0xa
  v_add_f32_dpp v25, v21, v21 row_half_mirror row_mask:0xf bank_mask:0xa
  v_add_f32_dpp v26, v22, v22 row_half_mirror row_mask:0xf bank_mask:0xa
  v_add_f32_dpp v27, v23, v23 row_half_mirror row_mask:0xf bank_mask:0xa
  v_add_f32_dpp v24, v24, v24 quad_perm:[2,3,0,1] row_mask:0xf bank_mask:0xf
  v_add_f32_dpp v25, v25, v25 quad_perm:[2,3,0,1] row_mask:0xf bank_mask:0xf
  v_add_f32_dpp v26, v26, v26 quad_perm:[2,3,0,1] row_mask:0xf bank_mask:0xf
  v_add_f32_dpp v27, v27, v27 quad_perm:[2,3,0,1] row_mask:0xf bank_mask:0xf
  v_cndmask_b32 v16, v24, v26, s[40:41]
  v_cndmask_b32 v17, v25, v27, s[40:41]
  s_nop 0
  v_add_f32_dpp v16, v16, v16 quad_perm:[1,0,3,2] row_mask:0xf bank_mask:0xf
  v_add_f32_dpp v17, v17, v17 quad_perm:[1,0,3,2] row_mask:0xf bank_mask:0xf
  v_cndmask_b32 v16, v16, v17, s[42:43]
  v_mov_b32 v17, v16
  s_nop 1
  v_permlane16_swap_b32 v16, v17
  v_add_f32 v3, v16, v17
  ds_write_b32 v2, v3 offset:512
  s_waitcnt vmcnt(5)
  buffer_load_dwordx4 v[96:99], v1, s[48:51], s58 offen offset:0 nt
  v_mov_b32 v16, 0
  v_dot2c_f32_bf16 v16, v128, v4
  v_dot2c_f32_bf16 v16, v129, v5
  v_dot2c_f32_bf16 v16, v130, v6
  v_dot2c_f32_bf16 v16, v131, v7
  v_mov_b32 v17, 0
  v_dot2c_f32_bf16 v17, v132, v4
  v_dot2c_f32_bf16 v17, v133, v5
  v_dot2c_f32_bf16 v17, v134, v6
  v_dot2c_f32_bf16 v17, v135, v7
  s_waitcnt vmcnt(5)
  buffer_load_dwordx4 v[100:103], v1, s[48:51], s58 offen offset:1024 nt
  v_mov_b32 v18, 0
  v_dot2c_f32_bf16 v18, v136, v4
  v_dot2c_f32_bf16 v18, v137, v5
  v_dot2c_f32_bf16 v18, v138, v6
  v_dot2c_f32_bf16 v18, v139, v7
  v_mov_b32 v19, 0
  v_dot2c_f32_bf16 v19, v140, v4
  v_dot2c_f32_bf16 v19, v141, v5
  v_dot2c_f32_bf16 v19, v142, v6
  v_dot2c_f32_bf16 v19, v143, v7
  s_waitcnt vmcnt(5)
  buffer_load_dwordx4 v[104:107], v1, s[48:51], s58 offen offset:2048 nt
  v_mov_b32 v20, 0
  v_dot2c_f32_bf16 v20, v144, v4
  v_dot2c_f32_bf16 v20, v145, v5
  v_dot2c_f32_bf16 v20, v146, v6
  v_dot2c_f32_bf16 v20, v147, v7
  v_mov_b32 v21, 0
  v_dot2c_f32_bf16 v21, v148, v4
  v_dot2c_f32_bf16 v21, v149, v5
  v_dot2c_f32_bf16 v21, v150, v6
  v_dot2c_f32_bf16 v21, v151, v7
  s_waitcnt vmcnt(5)
  buffer_load_dwordx4 v[108:111], v1, s[48:51], s58 offen offset:3072 nt
  v_mov_b32 v22, 0
  v_dot2c_f32_bf16 v22, v152, v4
  v_dot2c_f32_bf16 v22, v153, v5
  v_dot2c_f32_bf16 v22, v154, v6
  v_dot2c_f32_bf16 v22, v155, v7
  v_mov_b32 v23, 0
  v_dot2c_f32_bf16 v23, v156, v4
  v_dot2c_f32_bf16 v23, v157, v5
  v_dot2c_f32_bf16 v23, v158, v6
  v_dot2c_f32_bf16 v23, v159, v7
  s_waitcnt vmcnt(5)
  buffer_load_dwordx4 v[112:115], v1, s[48:51], s59 offen offset:0 nt
  v_mov_b32 v24, 0
  v_dot2c_f32_bf16 v24, v160, v4
  v_dot2c_f32_bf16 v24, v161, v5
  v_dot2c_f32_bf16 v24, v162, v6
  v_dot2c_f32_bf16 v24, v163, v7
  v_mov_b32 v25, 0
  v_dot2c_f32_bf16 v25, v164, v4
  v_dot2c_f32_bf16 v25, v165, v5
  v_dot2c_f32_bf16 v25, v166, v6
  v_dot2c_f32_bf16 v25, v167, v7
  s_waitcnt vmcnt(5)
  buffer_load_dwordx4 v[116:119], v1, s[48:51], s59 offen offset:1024 nt
  v_mov_b32 v26, 0
  v_dot2c_f32_bf16 v26, v168, v4
  v_dot2c_f32_bf16 v26, v169, v5
  v_dot2c_f32_bf16 v26, v170, v6
  v_dot2c_f32_bf16 v26, v171, v7
  v_mov_b32 v27, 0
  v_dot2c_f32_bf16 v27, v172, v4
  v_dot2c_f32_bf16 v27, v173, v5
  v_dot2c_f32_bf16 v27, v174, v6
  v_dot2c_f32_bf16 v27, v175, v7
  s_waitcnt vmcnt(5)
  buffer_load_dwordx4 v[120:123], v1, s[48:51], s59 offen offset:2048 nt
  v_mov_b32 v28, 0
  v_dot2c_f32_bf16 v28, v176, v4
  v_dot2c_f32_bf16 v28, v177, v5
  v_dot2c_f32_bf16 v28, v178, v6
  v_dot2c_f32_bf16 v28, v179, v7
  v_mov_b32 v29, 0
  v_dot2c_f32_bf16 v29, v180, v4
  v_dot2c_f32_bf16 v29, v181, v5
  v_dot2c_f32_bf16 v29, v182, v6
  v_dot2c_f32_bf16 v29, v183, v7
  s_waitcnt vmcnt(5)
  buffer_load_dwordx4 v[124:127], v1, s[48:51], s59 offen offset:3072 nt
  v_mov_b32 v30, 0
  v_dot2c_f32_bf16 v30, v184, v4
  v_dot2c_f32_bf16 v30, v185, v5
  v_dot2c_f32_bf16 v30, v186, v6
  v_dot2c_f32_bf16 v30, v187, v7
  v_mov_b32 v31, 0
  v_dot2c_f32_bf16 v31, v188, v4
  v_dot2c_f32_bf16 v31, v189, v5
  v_dot2c_f32_bf16 v31, v190, v6
  v_dot2c_f32_bf16 v31, v191, v7
  v_add_f32_dpp v16, v16, v16 row_ror:8 row_mask:0xf bank_mask:0x3
  v_add_f32_dpp v17, v17, v17 row_ror:8 row_mask:0xf bank_mask:0x3
  v_add_f32_dpp v18, v18, v18 row_ror:8 row_mask:0xf bank_mask:0x3
  v_add_f32_dpp v19, v19, v19 row_ror:8 row_mask:0xf bank_mask:0x3
  v_add_f32_dpp v20, v20, v20 row_ror:8 row_mask:0xf bank_mask:0x3
  v_add_f32_dpp v21, v21, v21 row_ror:8 row_mask:0xf bank_mask:0x3
  v_add_f32_dpp v22, v22, v22 row_ror:8 row_mask:0xf bank_mask:0x3
  v_add_f32_dpp v23, v23, v23 row_ror:8 row_mask:0xf bank_mask:0x3
  v_add_f32_dpp v16, v24, v24 row_ror:8 row_mask:0xf bank_mask:0xc
  v_add_f32_dpp v17, v25, v25 row_ror:8 row_mask:0xf bank_mask:0xc
  v_add_f32_dpp v18, v26, v26 row_ror:8 row_mask:0xf bank_mask:0xc
  v_add_f32_dpp v19, v27, v27 row_ror:8 row_mask:0xf bank_mask:0xc
  v_add_f32_dpp v20, v28, v28 row_ror:8 row_mask:0xf bank_mask:0xc
  v_add_f32_dpp v21, v29, v29 row_ror:8 row_mask:0xf bank_mask:0xc
  v_add_f32_dpp v22, v30, v30 row_ror:8 row_mask:0xf bank_mask:0xc
  v_add_f32_dpp v23, v31, v31 row_ror:8 row_mask:0xf bank_mask:0xc
  v_add_f32_dpp v24, v16, v16 row_half_mirror row_mask:0xf bank_mask:0x5
  v_add_f32_dpp v25, v17, v17 row_half_mirror row_mask:0xf bank_mask:0x5
  v_add_f32_dpp v26, v18, v18 row_half_mirror row_mask:0xf bank_mask:0x5
  v_add_f32_dpp v27, v19, v19 row_half_mirror row_mask:0xf bank_mask:0x5
  v_add_f32_dpp v24, v20, v20 row_half_mirror row_mask:0xf bank_mask:0xa
  v_add_f32_dpp v25, v21, v21 row_half_mirror row_mask:0xf bank_mask:0xa
  v_add_f32_dpp v26, v22, v22 row_half_mirror row_mask:0xf bank_mask:0xa
  v_add_f32_dpp v27, v23, v23 row_half_mirror row_mask:0xf bank_mask:0xa
  v_add_f32_dpp v24, v24, v24 quad_perm:[2,3,0,1] row_mask:0xf bank_mask:0xf
  v_add_f32_dpp v25, v25, v25 quad_perm:[2,3,0,1] row_mask:0xf bank_mask:0xf
  v_add_f32_dpp v26, v26, v26 quad_perm:[2,3,0,1] row_mask:0xf bank_mask:0xf
  v_add_f32_dpp v27, v27, v27 quad_perm:[2,3,0,1] row_mask:0xf bank_mask:0xf
  v_cndmask_b32 v16, v24, v26, s[40:41]
  v_cndmask_b32 v17, v25, v27, s[40:41]
  s_nop 0
  v_add_f32_dpp v16, v16, v16 quad_perm:[1,0,3,2] row_mask:0xf bank_mask:0xf
  v_add_f32_dpp v17, v17, v17 quad_perm:[1,0,3,2] row_mask:0xf bank_mask:0xf
  v_cndmask_b32 v16, v16, v17, s[42:43]
  v_mov_b32 v17, v16
  s_nop 1
  v_permlane16_swap_b32 v16, v17
  v_add_f32 v3, v16, v17
  ds_write_b32 v2, v3 offset:768
  s_waitcnt vmcnt(5)
  buffer_load_dwordx4 v[128:131], v1, s[48:51], s60 offen offset:0 nt
  v_mov_b32 v16, 0
  v_dot2c_f32_bf16 v16, v64, v4
  v_dot2c_f32_bf16 v16, v65, v5
  v_dot2c_f32_bf16 v16, v66, v6
  v_dot2c_f32_bf16 v16, v67, v7
  v_mov_b32 v17, 0
  v_dot2c_f32_bf16 v17, v68, v4
  v_dot2c_f32_bf16 v17, v69, v5
  v_dot2c_f32_bf16 v17, v70, v6
  v_dot2c_f32_bf16 v17, v71, v7
  s_waitcnt vmcnt(5)
  buffer_load_dwordx4 v[132:135], v1, s[48:51], s60 offen offset:1024 nt
  v_mov_b32 v18, 0
  v_dot2c_f32_bf16 v18, v72, v4
  v_dot2c_f32_bf16 v18, v73, v5
  v_dot2c_f32_bf16 v18, v74, v6
  v_dot2c_f32_bf16 v18, v75, v7
  v_mov_b32 v19, 0
  v_dot2c_f32_bf16 v19, v76, v4
  v_dot2c_f32_bf16 v19, v77, v5
  v_dot2c_f32_bf16 v19, v78, v6
  v_dot2c_f32_bf16 v19, v79, v7
  s_waitcnt vmcnt(5)
  buffer_load_dwordx4 v[136:139], v1, s[48:51], s60 offen offset:2048 nt
  v_mov_b32 v20, 0
  v_dot2c_f32_bf16 v20, v80, v4
  v_dot2c_f32_bf16 v20, v81, v5
  v_dot2c_f32_bf16 v20, v82, v6
  v_dot2c_f32_bf16 v20, v83, v7
  v_mov_b32 v21, 0
  v_dot2c_f32_bf16 v21, v84, v4
  v_dot2c_f32_bf16 v21, v85, v5
  v_dot2c_f32_bf16 v21, v86, v6
  v_dot2c_f32_bf16 v21, v87, v7
  s_waitcnt vmcnt(5)
  buffer_load_dwordx4 v[140:143], v1, s[48:51], s60 offen offset:3072 nt
  v_mov_b32 v22, 0
  v_dot2c_f32_bf16 v22, v88, v4
  v_dot2c_f32_bf16 v22, v89, v5
  v_dot2c_f32_bf16 v22, v90, v6
  v_dot2c_f32_bf16 v22, v91, v7
  v_mov_b32 v23, 0
  v_dot2c_f32_bf16 v23, v92, v4
  v_dot2c_f32_bf16 v23, v93, v5
  v_dot2c_f32_bf16 v23, v94, v6
  v_dot2c_f32_bf16 v23, v95, v7
  s_waitcnt vmcnt(5)
  buffer_load_dwordx4 v[144:147], v1, s[48:51], s61 offen offset:0 nt
  v_mov_b32 v24, 0
  v_dot2c_f32_bf16 v24, v96, v4
  v_dot2c_f32_bf16 v24, v97, v5
  v_dot2c_f32_bf16 v24, v98, v6
  v_dot2c_f32_bf16 v24, v99, v7
  v_mov_b32 v25, 0
  v_dot2c_f32_bf16 v25, v100, v4
  v_dot2c_f32_bf16 v25, v101, v5
  v_dot2c_f32_bf16 v25, v102, v6
  v_dot2c_f32_bf16 v25, v103, v7
  s_waitcnt vmcnt(5)
  buffer_load_dwordx4 v[148:151], v1, s[48:51], s61 offen offset:1024 nt
  v_mov_b32 v26, 0
  v_dot2c_f32_bf16 v26, v104, v4
  v_dot2c_f32_bf16 v26, v105, v5
  v_dot2c_f32_bf16 v26, v106, v6
  v_dot2c_f32_bf16 v26, v107, v7
  v_mov_b32 v27, 0
  v_dot2c_f32_bf16 v27, v108, v4
  v_dot2c_f32_bf16 v27, v109, v5
  v_dot2c_f32_bf16 v27, v110, v6
  v_dot2c_f32_bf16 v27, v111, v7
  s_waitcnt vmcnt(5)
  buffer_load_dwordx4 v[152:155], v1, s[48:51], s61 offen offset:2048 nt
  v_mov_b32 v28, 0
  v_dot2c_f32_bf16 v28, v112, v4
  v_dot2c_f32_bf16 v28, v113, v5
  v_dot2c_f32_bf16 v28, v114, v6
  v_dot2c_f32_bf16 v28, v115, v7
  v_mov_b32 v29, 0
  v_dot2c_f32_bf16 v29, v116, v4
  v_dot2c_f32_bf16 v29, v117, v5
  v_dot2c_f32_bf16 v29, v118, v6
  v_dot2c_f32_bf16 v29, v119, v7
  s_waitcnt vmcnt(5)
  buffer_load_dwordx4 v[156:159], v1, s[48:51], s61 offen offset:3072 nt
  v_mov_b32 v30, 0
  v_dot2c_f32_bf16 v30, v120, v4
  v_dot2c_f32_bf16 v30, v121, v5
  v_dot2c_f32_bf16 v30, v122, v6
  v_dot2c_f32_bf16 v30, v123, v7
  v_mov_b32 v31, 0
  v_dot2c_f32_bf16 v31, v124, v4
  v_dot2c_f32_bf16 v31, v125, v5
  v_dot2c_f32_bf16 v31, v126, v6
  v_dot2c_f32_bf16 v31, v127, v7
  v_add_f32_dpp v16, v16, v16 row_ror:8 row_mask:0xf bank_mask:0x3
  v_add_f32_dpp v17, v17, v17 row_ror:8 row_mask:0xf bank_mask:0x3
  v_add_f32_dpp v18, v18, v18 row_ror:8 row_mask:0xf bank_mask:0x3
  v_add_f32_dpp v19, v19, v19 row_ror:8 row_mask:0xf bank_mask:0x3
  v_add_f32_dpp v20, v20, v20 row_ror:8 row_mask:0xf bank_mask:0x3
  v_add_f32_dpp v21, v21, v21 row_ror:8 row_mask:0xf bank_mask:0x3
  v_add_f32_dpp v22, v22, v22 row_ror:8 row_mask:0xf bank_mask:0x3
  v_add_f32_dpp v23, v23, v23 row_ror:8 row_mask:0xf bank_mask:0x3
  v_add_f32_dpp v16, v24, v24 row_ror:8 row_mask:0xf bank_mask:0xc
  v_add_f32_dpp v17, v25, v25 row_ror:8 row_mask:0xf bank_mask:0xc
  v_add_f32_dpp v18, v26, v26 row_ror:8 row_mask:0xf bank_mask:0xc
  v_add_f32_dpp v19, v27, v27 row_ror:8 row_mask:0xf bank_mask:0xc
  v_add_f32_dpp v20, v28, v28 row_ror:8 row_mask:0xf bank_mask:0xc
  v_add_f32_dpp v21, v29, v29 row_ror:8 row_mask:0xf bank_mask:0xc
  v_add_f32_dpp v22, v30, v30 row_ror:8 row_mask:0xf bank_mask:0xc
  v_add_f32_dpp v23, v31, v31 row_ror:8 row_mask:0xf bank_mask:0xc
  v_add_f32_dpp v24, v16, v16 row_half_mirror row_mask:0xf bank_mask:0x5
  v_add_f32_dpp v25, v17, v17 row_half_mirror row_mask:0xf bank_mask:0x5
  v_add_f32_dpp v26, v18, v18 row_half_mirror row_mask:0xf bank_mask:0x5
  v_add_f32_dpp v27, v19, v19 row_half_mirror row_mask:0xf bank_mask:0x5
  v_add_f32_dpp v24, v20, v20 row_half_mirror row_mask:0xf bank_mask:0xa
  v_add_f32_dpp v25, v21, v21 row_half_mirror row_mask:0xf bank_mask:0xa
  v_add_f32_dpp v26, v22, v22 row_half_mirror row_mask:0xf bank_mask:0xa
  v_add_f32_dpp v27, v23, v23 row_half_mirror row_mask:0xf bank_mask:0xa
  v_add_f32_dpp v24, v24, v24 quad_perm:[2,3,0,1] row_mask:0xf bank_mask:0xf
  v_add_f32_dpp v25, v25, v25 quad_perm:[2,3,0,1] row_mask:0xf bank_mask:0xf
  v_add_f32_dpp v26, v26, v26 quad_perm:[2,3,0,1] row_mask:0xf bank_mask:0xf
  v_add_f32_dpp v27, v27, v27 quad_perm:[2,3,0,1] row_mask:0xf bank_mask:0xf
  v_cndmask_b32 v16, v24, v26, s[40:41]
  v_cndmask_b32 v17, v25, v27, s[40:41]
  s_nop 0
  v_add_f32_dpp v16, v16, v16 quad_perm:[1,0,3,2] row_mask:0xf bank_mask:0xf
  v_add_f32_dpp v17, v17, v17 quad_perm:[1,0,3,2] row_mask:0xf bank_mask:0xf
  v_cndmask_b32 v16, v16, v17, s[42:43]
  v_mov_b32 v17, v16
  s_nop 1
  v_permlane16_swap_b32 v16, v17
  v_add_f32 v3, v16, v17
  ds_write_b32 v2, v3 offset:1024
  s_waitcnt vmcnt(5)
  buffer_load_dwordx4 v[160:163], v1, s[48:51], s62 offen offset:0 nt
  v_mov_b32 v16, 0
  v_dot2c_f32_bf16 v16, v128, v4
  v_dot2c_f32_bf16 v16, v129, v5
  v_dot2c_f32_bf16 v16, v130, v6
  v_dot2c_f32_bf16 v16, v131, v7
  v_mov_b32 v17, 0
  v_dot2c_f32_bf16 v17, v132, v4
  v_dot2c_f32_bf16 v17, v133, v5
  v_dot2c_f32_bf16 v17, v134, v6
  v_dot2c_f32_bf16 v17, v135, v7
  s_waitcnt vmcnt(5)
  buffer_load_dwordx4 v[164:167], v1, s[48:51], s62 offen offset:1024 nt
  v_mov_b32 v18, 0
  v_dot2c_f32_bf16 v18, v136, v4
  v_dot2c_f32_bf16 v18, v137, v5
  v_dot2c_f32_bf16 v18, v138, v6
  v_dot2c_f32_bf16 v18, v139, v7
  v_mov_b32 v19, 0
  v_dot2c_f32_bf16 v19, v140, v4
  v_dot2c_f32_bf16 v19, v141, v5
  v_dot2c_f32_bf16 v19, v142, v6
  v_dot2c_f32_bf16 v19, v143, v7
  s_waitcnt vmcnt(5)
  buffer_load_dwordx4 v[168:171], v1, s[48:51], s62 offen offset:2048 nt
  v_mov_b32 v20, 0
  v_dot2c_f32_bf16 v20, v144, v4
  v_dot2c_f32_bf16 v20, v145, v5
  v_dot2c_f32_bf16 v20, v146, v6
  v_dot2c_f32_bf16 v20, v147, v7
  s_waitcnt vmcnt(5)
  buffer_load_dwordx4 v[172:175], v1, s[48:51], s62 offen offset:3072 nt
  v_mov_b32 v21, 0
  v_dot2c_f32_bf16 v21, v148, v4
  v_dot2c_f32_bf16 v21, v149, v5
  v_dot2c_f32_bf16 v21, v150, v6
  v_dot2c_f32_bf16 v21, v151, v7
  s_waitcnt vmcnt(5)
  buffer_load_dwordx4 v[176:179], v1, s[48:51], s63 offen offset:0 nt
  v_mov_b32 v22, 0
  v_dot2c_f32_bf16 v22, v152, v4
  v_dot2c_f32_bf16 v22, v153, v5
  v_dot2c_f32_bf16 v22, v154, v6
  v_dot2c_f32_bf16 v22, v155, v7
  s_waitcnt vmcnt(5)
  buffer_load_dwordx4 v[180:183], v1, s[48:51], s63 offen offset:1024 nt
  v_mov_b32 v23, 0
  v_dot2c_f32_bf16 v23, v156, v4
  v_dot2c_f32_bf16 v23, v157, v5
  v_dot2c_f32_bf16 v23, v158, v6
  v_dot2c_f32_bf16 v23, v159, v7
  s_waitcnt vmcnt(5)
  buffer_load_dwordx4 v[184:187], v1, s[48:51], s63 offen offset:2048 nt
  v_mov_b32 v24, 0
  v_dot2c_f32_bf16 v24, v160, v4
  v_dot2c_f32_bf16 v24, v161, v5
  v_dot2c_f32_bf16 v24, v162, v6
  v_dot2c_f32_bf16 v24, v163, v7
  s_waitcnt vmcnt(5)
  buffer_load_dwordx4 v[188:191], v1, s[48:51], s63 offen offset:3072 nt
  v_mov_b32 v25, 0
  v_dot2c_f32_bf16 v25, v164, v4
  v_dot2c_f32_bf16 v25, v165, v5
  v_dot2c_f32_bf16 v25, v166, v6
  v_dot2c_f32_bf16 v25, v167, v7
  s_waitcnt vmcnt(5)
  s_mov_b32 s44, s48
  s_mov_b32 s45, s49
  s_add_u32 s48, s48, 131072
  s_addc_u32 s49, s49, 0
  buffer_load_dwordx4 v[64:67], v1, s[48:51], s56 offen offset:0 nt
  v_mov_b32 v26, 0
  v_dot2c_f32_bf16 v26, v168, v4
  v_dot2c_f32_bf16 v26, v169, v5
  v_dot2c_f32_bf16 v26, v170, v6
  v_dot2c_f32_bf16 v26, v171, v7
  s_waitcnt vmcnt(5)
  buffer_load_dwordx4 v[68:71], v1, s[48:51], s56 offen offset:1024 nt
  v_mov_b32 v27, 0
  v_dot2c_f32_bf16 v27, v172, v4
  v_dot2c_f32_bf16 v27, v173, v5
  v_dot2c_f32_bf16 v27, v174, v6
  v_dot2c_f32_bf16 v27, v175, v7
  s_waitcnt vmcnt(5)
  buffer_load_dwordx4 v[72:75], v1, s[48:51], s56 offen offset:2048 nt
  v_mov_b32 v28, 0
  v_dot2c_f32_bf16 v28, v176, v4
  v_dot2c_f32_bf16 v28, v177, v5
  v_dot2c_f32_bf16 v28, v178, v6
  v_dot2c_f32_bf16 v28, v179, v7
  s_waitcnt vmcnt(5)
  buffer_load_dwordx4 v[76:79], v1, s[48:51], s56 offen offset:3072 nt
  v_mov_b32 v29, 0
  v_dot2c_f32_bf16 v29, v180, v4
  v_dot2c_f32_bf16 v29, v181, v5
  v_dot2c_f32_bf16 v29, v182, v6
  v_dot2c_f32_bf16 v29, v183, v7
  s_waitcnt vmcnt(5)
  buffer_load_dwordx4 v[80:83], v1, s[48:51], s57 offen offset:0 nt
  v_mov_b32 v30, 0
  v_dot2c_f32_bf16 v30, v184, v4
  v_dot2c_f32_bf16 v30, v185, v5
  v_dot2c_f32_bf16 v30, v186, v6
  v_dot2c_f32_bf16 v30, v187, v7
  s_waitcnt vmcnt(5)
  buffer_load_dwordx4 v[84:87], v1, s[48:51], s57 offen offset:1024 nt
  v_mov_b32 v31, 0
  v_dot2c_f32_bf16 v31, v188, v4
  v_dot2c_f32_bf16 v31, v189, v5
  v_dot2c_f32_bf16 v31, v190, v6
  v_dot2c_f32_bf16 v31, v191, v7
  v_add_f32_dpp v16, v16, v16 row_ror:8 row_mask:0xf bank_mask:0x3
  v_add_f32_dpp v17, v17, v17 row_ror:8 row_mask:0xf bank_mask:0x3
  v_add_f32_dpp v18, v18, v18 row_ror:8 row_mask:0xf bank_mask:0x3
  v_add_f32_dpp v19, v19, v19 row_ror:8 row_mask:0xf bank_mask:0x3
  v_add_f32_dpp v20, v20, v20 row_ror:8 row_mask:0xf bank_mask:0x3
  v_add_f32_dpp v21, v21, v21 row_ror:8 row_mask:0xf bank_mask:0x3
  v_add_f32_dpp v22, v22, v22 row_ror:8 row_mask:0xf bank_mask:0x3
  v_add_f32_dpp v23, v23, v23 row_ror:8 row_mask:0xf bank_mask:0x3
  v_add_f32_dpp v16, v24, v24 row_ror:8 row_mask:0xf bank_mask:0xc
  v_add_f32_dpp v17, v25, v25 row_ror:8 row_mask:0xf bank_mask:0xc
  v_add_f32_dpp v18, v26, v26 row_ror:8 row_mask:0xf bank_mask:0xc
  v_add_f32_dpp v19, v27, v27 row_ror:8 row_mask:0xf bank_mask:0xc
  v_add_f32_dpp v20, v28, v28 row_ror:8 row_mask:0xf bank_mask:0xc
  v_add_f32_dpp v21, v29, v29 row_ror:8 row_mask:0xf bank_mask:0xc
  v_add_f32_dpp v22, v30, v30 row_ror:8 row_mask:0xf bank_mask:0xc
  v_add_f32_dpp v23, v31, v31 row_ror:8 row_mask:0xf bank_mask:0xc
  v_add_f32_dpp v24, v16, v16 row_half_mirror row_mask:0xf bank_mask:0x5
  v_add_f32_dpp v25, v17, v17 row_half_mirror row_mask:0xf bank_mask:0x5
  v_add_f32_dpp v26, v18, v18 row_half_mirror row_mask:0xf bank_mask:0x5
  v_add_f32_dpp v27, v19, v19 row_half_mirror row_mask:0xf bank_mask:0x5
  v_add_f32_dpp v24, v20, v20 row_half_mirror row_mask:0xf bank_mask:0xa
  v_add_f32_dpp v25, v21, v21 row_half_mirror row_mask:0xf bank_mask:0xa
  v_add_f32_dpp v26, v22, v22 row_half_mirror row_mask:0xf bank_mask:0xa
  v_add_f32_dpp v27, v23, v23 row_half_mirror row_mask:0xf bank_mask:0xa
  v_add_f32_dpp v24, v24, v24 quad_perm:[2,3,0,1] row_mask:0xf bank_mask:0xf
  v_add_f32_dpp v25, v25, v25 quad_perm:[2,3,0,1] row_mask:0xf bank_mask:0xf
  v_add_f32_dpp v26, v26, v26 quad_perm:[2,3,0,1] row_mask:0xf bank_mask:0xf
  v_add_f32_dpp v27, v27, v27 quad_perm:[2,3,0,1] row_mask:0xf bank_mask:0xf
  v_cndmask_b32 v16, v24, v26, s[40:41]
  v_cndmask_b32 v17, v25, v27, s[40:41]
  s_nop 0
  v_add_f32_dpp v16, v16, v16 quad_perm:[1,0,3,2] row_mask:0xf bank_mask:0xf
  v_add_f32_dpp v17, v17, v17 quad_perm:[1,0,3,2] row_mask:0xf bank_mask:0xf
  v_cndmask_b32 v16, v16, v17, s[42:43]
  v_mov_b32 v17, v16
  s_nop 1
  v_permlane16_swap_b32 v16, v17
  v_add_f32 v3, v16, v17
  ds_write_b32 v2, v3 offset:1280
  s_mov_b32 s44, s48
  s_mov_b32 s45, s49
  s_add_u32 s48, s48, 131072
  s_addc_u32 s49, s49, 0
  v_add_u32 v2, 1536, v2
  s_mov_b32 s34, 3
L_kloop:
  s_waitcnt vmcnt(5)
  buffer_load_dwordx4 v[88:91], v1, s[44:47], s57 offen offset:2048 nt
  v_mov_b32 v16, 0
  v_dot2c_f32_bf16 v16, v64, v4
  v_dot2c_f32_bf16 v16, v65, v5
  v_dot2c_f32_bf16 v16, v66, v6
  v_dot2c_f32_bf16 v16, v67, v7
  s_waitcnt vmcnt(5)
  buffer_load_dwordx4 v[92:95], v1, s[44:47], s57 offen offset:3072 nt
  v_mov_b32 v17, 0
  v_dot2c_f32_bf16 v17, v68, v4
  v_dot2c_f32_bf16 v17, v69, v5
  v_dot2c_f32_bf16 v17, v70, v6
  v_dot2c_f32_bf16 v17, v71, v7
  s_waitcnt vmcnt(5)
  buffer_load_dwordx4 v[96:99], v1, s[44:47], s58 offen offset:0 nt
  v_mov_b32 v18, 0
  v_dot2c_f32_bf16 v18, v72, v4
  v_dot2c_f32_bf16 v18, v73, v5
  v_dot2c_f32_bf16 v18, v74, v6
  v_dot2c_f32_bf16 v18, v75, v7
  s_waitcnt vmcnt(5)
  buffer_load_dwordx4 v[100:103], v1, s[44:47], s58 offen offset:1024 nt
  v_mov_b32 v19, 0
  v_dot2c_f32_bf16 v19, v76, v4
  v_dot2c_f32_bf16 v19, v77, v5
  v_dot2c_f32_bf16 v19, v78, v6
  v_dot2c_f32_bf16 v19, v79, v7
  s_waitcnt vmcnt(5)
  buffer_load_dwordx4 v[104:107], v1, s[44:47], s58 offen offset:2048 nt
  v_mov_b32 v20, 0
  v_dot2c_f32_bf16 v20, v80, v4
  v_dot2c_f32_bf16 v20, v81, v5
  v_dot2c_f32_bf16 v20, v82, v6
  v_dot2c_f32_bf16 v20, v83, v7
  s_waitcnt vmcnt(5)
  buffer_load_dwordx4 v[108:111], v1, s[44:47], s58 offen offset:3072 nt
  v_mov_b32 v21, 0
  v_dot2c_f32_bf16 v21, v84, v4
  v_dot2c_f32_bf16 v21, v85, v5
  v_dot2c_f32_bf16 v21, v86, v6
  v_dot2c_f32_bf16 v21, v87, v7
  s_waitcnt vmcnt(5)
  buffer_load_dwordx4 v[112:115], v1, s[44:47], s59 offen offset:0 nt
  v_mov_b32 v22, 0
  v_dot2c_f32_bf16 v22, v88, v4
  v_dot2c_f32_bf16 v22, v89, v5
  v_dot2c_f32_bf16 v22, v90, v6
  v_dot2c_f32_bf16 v22, v91, v7
  s_waitcnt vmcnt(5)
  buffer_load_dwordx4 v[116:119], v1, s[44:47], s59 offen offset:1024 nt
  v_mov_b32 v23, 0
  v_dot2c_f32_bf16 v23, v92, v4
  v_dot2c_f32_bf16 v23, v93, v5
  v_dot2c_f32_bf16 v23, v94, v6
  v_dot2c_f32_bf16 v23, v95, v7
  s_waitcnt vmcnt(5)
  buffer_load_dwordx4 v[120:123], v1, s[44:47], s59 offen offset:2048 nt
  v_mov_b32 v24, 0
  v_dot2c_f32_bf16 v24, v96, v4
  v_dot2c_f32_bf16 v24, v97, v5
  v_dot2c_f32_bf16 v24, v98, v6
  v_dot2c_f32_bf16 v24, v99, v7
  s_waitcnt vmcnt(5)
  buffer_load_dwordx4 v[124:127], v1, s[44:47], s59 offen offset:3072 nt
  v_mov_b32 v25, 0
  v_dot2c_f32_bf16 v25, v100, v4
  v_dot2c_f32_bf16 v25, v101, v5
  v_dot2c_f32_bf16 v25, v102, v6
  v_dot2c_f32_bf16 v25, v103, v7
  s_waitcnt vmcnt(5)
  buffer_load_dwordx4 v[128:131], v1, s[44:47], s60 offen offset:0 nt
  v_mov_b32 v26, 0
  v_dot2c_f32_bf16 v26, v104, v4
  v_dot2c_f32_bf16 v26, v105, v5
  v_dot2c_f32_bf16 v26, v106, v6
  v_dot2c_f32_bf16 v26, v107, v7
  s_waitcnt vmcnt(5)
  buffer_load_dwordx4 v[132:135], v1, s[44:47], s60 offen offset:1024 nt
  v_mov_b32 v27, 0
  v_dot2c_f32_bf16 v27, v108, v4
  v_dot2c_f32_bf16 v27, v109, v5
  v_dot2c_f32_bf16 v27, v110, v6
  v_dot2c_f32_bf16 v27, v111, v7
  s_waitcnt vmcnt(5)
  buffer_load_dwordx4 v[136:139], v1, s[44:47], s60 offen offset:2048 nt
  v_mov_b32 v28, 0
  v_dot2c_f32_bf16 v28, v112, v4
  v_dot2c_f32_bf16 v28, v113, v5
  v_dot2c_f32_bf16 v28, v114, v6
  v_dot2c_f32_bf16 v28, v115, v7
  s_waitcnt vmcnt(5)
  buffer_load_dwordx4 v[140:143], v1, s[44:47], s60 offen offset:3072 nt
  v_mov_b32 v29, 0
  v_dot2c_f32_bf16 v29, v116, v4
  v_dot2c_f32_bf16 v29, v117, v5
  v_dot2c_f32_bf16 v29, v118, v6
  v_dot2c_f32_bf16 v29, v119, v7
  s_waitcnt vmcnt(5)
  buffer_load_dwordx4 v[144:147], v1, s[44:47], s61 offen offset:0 nt
  v_mov_b32 v30, 0
  v_dot2c_f32_bf16 v30, v120, v4
  v_dot2c_f32_bf16 v30, v121, v5
  v_dot2c_f32_bf16 v30, v122, v6
  v_dot2c_f32_bf16 v30, v123, v7
  s_waitcnt vmcnt(5)
  buffer_load_dwordx4 v[148:151], v1, s[44:47], s61 offen offset:1024 nt
  v_mov_b32 v31, 0
  v_dot2c_f32_bf16 v31, v124, v4
  v_dot2c_f32_bf16 v31, v125, v5
  v_dot2c_f32_bf16 v31, v126, v6
  v_dot2c_f32_bf16 v31, v127, v7
  v_add_f32_dpp v16, v16, v16 row_ror:8 row_mask:0xf bank_mask:0x3
  v_add_f32_dpp v17, v17, v17 row_ror:8 row_mask:0xf bank_mask:0x3
  v_add_f32_dpp v18, v18, v18 row_ror:8 row_mask:0xf bank_mask:0x3
  v_add_f32_dpp v19, v19, v19 row_ror:8 row_mask:0xf bank_mask:0x3
  v_add_f32_dpp v20, v20, v20 row_ror:8 row_mask:0xf bank_mask:0x3
  v_add_f32_dpp v21, v21, v21 row_ror:8 row_mask:0xf bank_mask:0x3
  v_add_f32_dpp v22, v22, v22 row_ror:8 row_mask:0xf bank_mask:0x3
  v_add_f32_dpp v23, v23, v23 row_ror:8 row_mask:0xf bank_mask:0x3
  v_add_f32_dpp v16, v24, v24 row_ror:8 row_mask:0xf bank_mask:0xc
  v_add_f32_dpp v17, v25, v25 row_ror:8 row_mask:0xf bank_mask:0xc
  v_add_f32_dpp v18, v26, v26 row_ror:8 row_mask:0xf bank_mask:0xc
  v_add_f32_dpp v19, v27, v27 row_ror:8 row_mask:0xf bank_mask:0xc
  v_add_f32_dpp v20, v28, v28 row_ror:8 row_mask:0xf bank_mask:0xc
  v_add_f32_dpp v21, v29, v29 row_ror:8 row_mask:0xf bank_mask:0xc
  v_add_f32_dpp v22, v30, v30 row_ror:8 row_mask:0xf bank_mask:0xc
  v_add_f32_dpp v23, v31, v31 row_ror:8 row_mask:0xf bank_mask:0xc
  v_add_f32_dpp v24, v16, v16 row_half_mirror row_mask:0xf bank_mask:0x5
  v_add_f32_dpp v25, v17, v17 row_half_mirror row_mask:0xf bank_mask:0x5
  v_add_f32_dpp v26, v18, v18 row_half_mirror row_mask:0xf bank_mask:0x5
  v_add_f32_dpp v27, v19, v19 row_half_mirror row_mask:0xf bank_mask:0x5
  v_add_f32_dpp v24, v20, v20 row_half_mirror row_mask:0xf bank_mask:0xa
  v_add_f32_dpp v25, v21, v21 row_half_mirror row_mask:0xf bank_mask:0xa
  v_add_f32_dpp v26, v22, v22 row_half_mirror row_mask:0xf bank_mask:0xa
  v_add_f32_dpp v27, v23, v23 row_half_mirror row_mask:0xf bank_mask:0xa
  v_add_f32_dpp v24, v24, v24 quad_perm:[2,3,0,1] row_mask:0xf bank_mask:0xf
  v_add_f32_dpp v25, v25, v25 quad_perm:[2,3,0,1] row_mask:0xf bank_mask:0xf
  v_add_f32_dpp v26, v26, v26 quad_perm:[2,3,0,1] row_mask:0xf bank_mask:0xf
  v_add_f32_dpp v27, v27, v27 quad_perm:[2,3,0,1] row_mask:0xf bank_mask:0xf
  v_cndmask_b32 v16, v24, v26, s[40:41]
  v_cndmask_b32 v17, v25, v27, s[40:41]
  s_nop 0
  v_add_f32_dpp v16, v16, v16 quad_perm:[1,0,3,2] row_mask:0xf bank_mask:0xf
  v_add_f32_dpp v17, v17, v17 quad_perm:[1,0,3,2] row_mask:0xf bank_mask:0xf
  v_cndmask_b32 v16, v16, v17, s[42:43]
  v_mov_b32 v17, v16
  s_nop 1
  v_permlane16_swap_b32 v16, v17
  v_add_f32 v3, v16, v17
  ds_write_b32 v2, v3 offset:0
  s_waitcnt vmcnt(5)
  buffer_load_dwordx4 v[152:155], v1, s[44:47], s61 offen offset:2048 nt
  v_mov_b32 v16, 0
  v_dot2c_f32_bf16 v16, v128, v4
  v_dot2c_f32_bf16 v16, v129, v5
  v_dot2c_f32_bf16 v16, v130, v6
  v_dot2c_f32_bf16 v16, v131, v7
  s_waitcnt vmcnt(5)
  buffer_load_dwordx4 v[156:159], v1, s[44:47], s61 offen offset:3072 nt
  v_mov_b32 v17, 0
  v_dot2c_f32_bf16 v17, v132, v4
  v_dot2c_f32_bf16 v17, v133, v5
  v_dot2c_f32_bf16 v17, v134, v6
  v_dot2c_f32_bf16 v17, v135, v7
  s_waitcnt vmcnt(5)
  buffer_load_dwordx4 v[160:163], v1, s[44:47], s62 offen offset:0 nt
  v_mov_b32 v18, 0
  v_dot2c_f32_bf16 v18, v136, v4
  v_dot2c_f32_bf16 v18, v137, v5
  v_dot2c_f32_bf16 v18, v138, v6
  v_dot2c_f32_bf16 v18, v139, v7
  s_waitcnt vmcnt(5)
  buffer_load_dwordx4 v[164:167], v1, s[44:47], s62 offen offset:1024 nt
  v_mov_b32 v19, 0
  v_dot2c_f32_bf16 v19, v140, v4
  v_dot2c_f32_bf16 v19, v141, v5
  v_dot2c_f32_bf16 v19, v142, v6
  v_dot2c_f32_bf16 v19, v143, v7
  s_waitcnt vmcnt(5)
  buffer_load_dwordx4 v[168:171], v1, s[44:47], s62 offen offset:2048 nt
  v_mov_b32 v20, 0
  v_dot2c_f32_bf16 v20, v144, v4
  v_dot2c_f32_bf16 v20, v145, v5
  v_dot2c_f32_bf16 v20, v146, v6
  v_dot2c_f32_bf16 v20, v147, v7
  s_waitcnt vmcnt(5)
  buffer_load_dwordx4 v[172:175], v1, s[44:47], s62 offen offset:3072 nt
  v_mov_b32 v21, 0
  v_dot2c_f32_bf16 v21, v148, v4
  v_dot2c_f32_bf16 v21, v149, v5
  v_dot2c_f32_bf16 v21, v150, v6
  v_dot2c_f32_bf16 v21, v151, v7
  s_waitcnt vmcnt(5)
  buffer_load_dwordx4 v[176:179], v1, s[44:47], s63 offen offset:0 nt
  v_mov_b32 v22, 0
  v_dot2c_f32_bf16 v22, v152, v4
  v_dot2c_f32_bf16 v22, v153, v5
  v_dot2c_f32_bf16 v22, v154, v6
  v_dot2c_f32_bf16 v22, v155, v7
  s_waitcnt vmcnt(5)
  buffer_load_dwordx4 v[180:183], v1, s[44:47], s63 offen offset:1024 nt
  v_mov_b32 v23, 0
  v_dot2c_f32_bf16 v23, v156, v4
  v_dot2c_f32_bf16 v23, v157, v5
  v_dot2c_f32_bf16 v23, v158, v6
  v_dot2c_f32_bf16 v23, v159, v7
  s_waitcnt vmcnt(5)
  buffer_load_dwordx4 v[184:187], v1, s[44:47], s63 offen offset:2048 nt
  v_mov_b32 v24, 0
  v_dot2c_f32_bf16 v24, v160, v4
  v_dot2c_f32_bf16 v24, v161, v5
  v_dot2c_f32_bf16 v24, v162, v6
  v_dot2c_f32_bf16 v24, v163, v7
  s_waitcnt vmcnt(5)
  buffer_load_dwordx4 v[188:191], v1, s[44:47], s63 offen offset:3072 nt
  v_mov_b32 v25, 0
  v_dot2c_f32_bf16 v25, v164, v4
  v_dot2c_f32_bf16 v25, v165, v5
  v_dot2c_f32_bf16 v25, v166, v6
  v_dot2c_f32_bf16 v25, v167, v7
  s_waitcnt vmcnt(5)
  buffer_load_dwordx4 v[64:67], v1, s[48:51], s56 offen offset:0 nt
  v_mov_b32 v26, 0
  v_dot2c_f32_bf16 v26, v168, v4
  v_dot2c_f32_bf16 v26, v169, v5
  v_dot2c_f32_bf16 v26, v170, v6
  v_dot2c_f32_bf16 v26, v171, v7
  s_waitcnt vmcnt(5)
  buffer_load_dwordx4 v[68:71], v1, s[48:51], s56 offen offset:1024 nt
  v_mov_b32 v27, 0
  v_dot2c_f32_bf16 v27, v172, v4
  v_dot2c_f32_bf16 v27, v173, v5
  v_dot2c_f32_bf16 v27, v174, v6
  v_dot2c_f32_bf16 v27, v175, v7
  s_waitcnt vmcnt(5)
  buffer_load_dwordx4 v[72:75], v1, s[48:51], s56 offen offset:2048 nt
  v_mov_b32 v28, 0
  v_dot2c_f32_bf16 v28, v176, v4
  v_dot2c_f32_bf16 v28, v177, v5
  v_dot2c_f32_bf16 v28, v178, v6
  v_dot2c_f32_bf16 v28, v179, v7
  s_waitcnt vmcnt(5)
  buffer_load_dwordx4 v[76:79], v1, s[48:51], s56 offen offset:3072 nt
  v_mov_b32 v29, 0
  v_dot2c_f32_bf16 v29, v180, v4
  v_dot2c_f32_bf16 v29, v181, v5
  v_dot2c_f32_bf16 v29, v182, v6
  v_dot2c_f32_bf16 v29, v183, v7
  s_waitcnt vmcnt(5)
  buffer_load_dwordx4 v[80:83], v1, s[48:51], s57 offen offset:0 nt
  v_mov_b32 v30, 0
  v_dot2c_f32_bf16 v30, v184, v4
  v_dot2c_f32_bf16 v30, v185, v5
  v_dot2c_f32_bf16 v30, v186, v6
  v_dot2c_f32_bf16 v30, v187, v7
  s_waitcnt vmcnt(5)
  buffer_load_dwordx4 v[84:87], v1, s[48:51], s57 offen offset:1024 nt
  v_mov_b32 v31, 0
  v_dot2c_f32_bf16 v31, v188, v4
  v_dot2c_f32_bf16 v31, v189, v5
  v_dot2c_f32_bf16 v31, v190, v6
  v_dot2c_f32_bf16 v31, v191, v7
  v_add_f32_dpp v16, v16, v16 row_ror:8 row_mask:0xf bank_mask:0x3
  v_add_f32_dpp v17, v17, v17 row_ror:8 row_mask:0xf bank_mask:0x3
  v_add_f32_dpp v18, v18, v18 row_ror:8 row_mask:0xf bank_mask:0x3
  v_add_f32_dpp v19, v19, v19 row_ror:8 row_mask:0xf bank_mask:0x3
  v_add_f32_dpp v20, v20, v20 row_ror:8 row_mask:0xf bank_mask:0x3
  v_add_f32_dpp v21, v21, v21 row_ror:8 row_mask:0xf bank_mask:0x3
  v_add_f32_dpp v22, v22, v22 row_ror:8 row_mask:0xf bank_mask:0x3
  v_add_f32_dpp v23, v23, v23 row_ror:8 row_mask:0xf bank_mask:0x3
  v_add_f32_dpp v16, v24, v24 row_ror:8 row_mask:0xf bank_mask:0xc
  v_add_f32_dpp v17, v25, v25 row_ror:8 row_mask:0xf bank_mask:0xc
  v_add_f32_dpp v18, v26, v26 row_ror:8 row_mask:0xf bank_mask:0xc
  v_add_f32_dpp v19, v27, v27 row_ror:8 row_mask:0xf bank_mask:0xc
  v_add_f32_dpp v20, v28, v28 row_ror:8 row_mask:0xf bank_mask:0xc
  v_add_f32_dpp v21, v29, v29 row_ror:8 row_mask:0xf bank_mask:0xc
  v_add_f32_dpp v22, v30, v30 row_ror:8 row_mask:0xf bank_mask:0xc
  v_add_f32_dpp v23, v31, v31 row_ror:8 row_mask:0xf bank_mask:0xc
  v_add_f32_dpp v24, v16, v16 row_half_mirror row_mask:0xf bank_mask:0x5
  v_add_f32_dpp v25, v17, v17 row_half_mirror row_mask:0xf bank_mask:0x5
  v_add_f32_dpp v26, v18, v18 row_half_mirror row_mask:0xf bank_mask:0x5
  v_add_f32_dpp v27, v19, v19 row_half_mirror row_mask:0xf bank_mask:0x5
  v_add_f32_dpp v24, v20, v20 row_half_mirror row_mask:0xf bank_mask:0xa
  v_add_f32_dpp v25, v21, v21 row_half_mirror row_mask:0xf bank_mask:0xa
  v_add_f32_dpp v26, v22, v22 row_half_mirror row_mask:0xf bank_mask:0xa
  v_add_f32_dpp v27, v23, v23 row_half_mirror row_mask:0xf bank_mask:0xa
  v_add_f32_dpp v24, v24, v24 quad_perm:[2,3,0,1] row_mask:0xf bank_mask:0xf
  v_add_f32_dpp v25, v25, v25 quad_perm:[2,3,0,1] row_mask:0xf bank_mask:0xf
  v_add_f32_dpp v26, v26, v26 quad_perm:[2,3,0,1] row_mask:0xf bank_mask:0xf
  v_add_f32_dpp v27, v27, v27 quad_perm:[2,3,0,1] row_mask:0xf bank_mask:0xf
  v_cndmask_b32 v16, v24, v26, s[40:41]
  v_cndmask_b32 v17, v25, v27, s[40:41]
  s_nop 0
  v_add_f32_dpp v16, v16, v16 quad_perm:[1,0,3,2] row_mask:0xf bank_mask:0xf
  v_add_f32_dpp v17, v17, v17 quad_perm:[1,0,3,2] row_mask:0xf bank_mask:0xf
  v_cndmask_b32 v16, v16, v17, s[42:43]
  v_mov_b32 v17, v16
  s_nop 1
  v_permlane16_swap_b32 v16, v17
  v_add_f32 v3, v16, v17
  ds_write_b32 v2, v3 offset:256
  v_add_u32 v2, 512, v2
  s_mov_b32 s44, s48
  s_mov_b32 s45, s49
  s_add_u32 s48, s48, 131072
  s_addc_u32 s49, s49, 0
  s_add_u32 s34, s34, 1
  s_cmp_eq_u32 s34, 7
  s_cselect_b32 s48, s52, s48
  s_cselect_b32 s49, s53, s49
  s_cmp_lt_u32 s34, 8
  s_cbranch_scc1 L_kloop
  v_subrev_u32 v2, 4096, v2
  ds_read_b32 v32, v2 offset:0
  ds_read_b32 v33, v2 offset:256
  ds_read_b32 v34, v2 offset:512
  ds_read_b32 v35, v2 offset:768
  ds_read_b32 v36, v2 offset:1024
  ds_read_b32 v37, v2 offset:1280
  ds_read_b32 v38, v2 offset:1536
  ds_read_b32 v39, v2 offset:1792
  ds_read_b32 v40, v2 offset:2048
  ds_read_b32 v41, v2 offset:2304
  ds_read_b32 v42, v2 offset:2560
  ds_read_b32 v43, v2 offset:2816
  ds_read_b32 v44, v2 offset:3072
  ds_read_b32 v45, v2 offset:3328
  ds_read_b32 v46, v2 offset:3584
  ds_read_b32 v47, v2 offset:3840
  s_waitcnt vmcnt(4)
  buffer_load_dwordx4 v[88:91], v1, s[44:47], s57 offen offset:2048 nt
  s_waitcnt lgkmcnt(0)
  v_cvt_pk_bf16_f32 v3, v32, v33
  v_lshlrev_b32 v32, 16, v3
  v_and_b32 v33, 0xffff0000, v3
  v_cvt_pk_bf16_f32 v3, v34, v35
  v_lshlrev_b32 v34, 16, v3
  v_and_b32 v35, 0xffff0000, v3
  v_cvt_pk_bf16_f32 v3, v36, v37
  v_lshlrev_b32 v36, 16, v3
  v_and_b32 v37, 0xffff0000, v3
  v_cvt_pk_bf16_f32 v3, v38, v39
  v_lshlrev_b32 v38, 16, v3
  v_and_b32 v39, 0xffff0000, v3
  v_cvt_pk_bf16_f32 v3, v40, v41
  v_lshlrev_b32 v40, 16, v3
  v_and_b32 v41, 0xffff0000, v3
  v_cvt_pk_bf16_f32 v3, v42, v43
  v_lshlrev_b32 v42, 16, v3
  v_and_b32 v43, 0xffff0000, v3
  v_cvt_pk_bf16_f32 v3, v44, v45
  v_lshlrev_b32 v44, 16, v3
  v_and_b32 v45, 0xffff0000, v3
  v_cvt_pk_bf16_f32 v3, v46, v47
  v_lshlrev_b32 v46, 16, v3
  v_and_b32 v47, 0xffff0000, v3
  v_max3_f32 v16, v32, v33, v34
  v_max3_f32 v16, v16, v35, v36
  v_max3_f32 v16, v16, v37, v38
  v_max3_f32 v16, v16, v39, v40
  v_max3_f32 v16, v16, v41, v42
  v_max3_f32 v16, v16, v43, v44
  v_max3_f32 v16, v16, v45, v46
  v_max_f32 v16, v16, v47
  s_nop 1
  v_max_f32_dpp v16, v16, v16 row_ror:8 row_mask:0xf bank_mask:0xf
  s_nop 1
  v_max_f32_dpp v16, v16, v16 row_ror:4 row_mask:0xf bank_mask:0xf
  s_nop 1
  v_max_f32_dpp v16, v16, v16 row_ror:2 row_mask:0xf bank_mask:0xf
  s_nop 1
  v_max_f32_dpp v16, v16, v16 row_ror:1 row_mask:0xf bank_mask:0xf
  v_mov_b32 v17, v16
  s_nop 1
  v_permlane32_swap_b32 v16, v17
  v_max_f32 v16, v16, v17
  s_waitcnt vmcnt(4)
  buffer_load_dwordx4 v[92:95], v1, s[44:47], s57 offen offset:3072 nt
  s_mov_b32 s35, 0x3db8aa3b
  v_sub_f32 v32, v32, v16
  v_sub_f32 v33, v33, v16
  v_sub_f32 v34, v34, v16
  v_sub_f32 v35, v35, v16
  v_sub_f32 v36, v36, v16
  v_sub_f32 v37, v37, v16
  v_sub_f32 v38, v38, v16
  v_sub_f32 v39, v39, v16
  v_sub_f32 v40, v40, v16
  v_sub_f32 v41, v41, v16
  v_sub_f32 v42, v42, v16
  v_sub_f32 v43, v43, v16
  v_sub_f32 v44, v44, v16
  v_sub_f32 v45, v45, v16
  v_sub_f32 v46, v46, v16
  v_sub_f32 v47, v47, v16
  v_mul_f32 v32, s35, v32
  v_mul_f32 v33, s35, v33
  v_mul_f32 v34, s35, v34
  v_mul_f32 v35, s35, v35
  v_mul_f32 v36, s35, v36
  v_mul_f32 v37, s35, v37
  v_mul_f32 v38, s35, v38
  v_mul_f32 v39, s35, v39
  v_mul_f32 v40, s35, v40
  v_mul_f32 v41, s35, v41
  v_mul_f32 v42, s35, v42
  v_mul_f32 v43, s35, v43
  v_mul_f32 v44, s35, v44
  v_mul_f32 v45, s35, v45
  v_mul_f32 v46, s35, v46
  v_mul_f32 v47, s35, v47
  v_exp_f32 v32, v32
  v_exp_f32 v33, v33
  v_exp_f32 v34, v34
  v_exp_f32 v35, v35
  v_exp_f32 v36, v36
  v_exp_f32 v37, v37
  v_exp_f32 v38, v38
  v_exp_f32 v39, v39
  v_exp_f32 v40, v40
  v_exp_f32 v41, v41
  v_exp_f32 v42, v42
  v_exp_f32 v43, v43
  v_exp_f32 v44, v44
  v_exp_f32 v45, v45
  v_exp_f32 v46, v46
  v_exp_f32 v47, v47
  s_waitcnt vmcnt(4)
  buffer_load_dwordx4 v[96:99], v1, s[44:47], s58 offen offset:0 nt
  v_add_f32 v17, v32, v33
  v_add_f32 v17, v17, v34
  v_add_f32 v17, v17, v35
  v_add_f32 v17, v17, v36
  v_add_f32 v17, v17, v37
  v_add_f32 v17, v17, v38
  v_add_f32 v17, v17, v39
  v_add_f32 v17, v17, v40
  v_add_f32 v17, v17, v41
  v_add_f32 v17, v17, v42
  v_add_f32 v17, v17, v43
  v_add_f32 v17, v17, v44
  v_add_f32 v17, v17, v45
  v_add_f32 v17, v17, v46
  v_add_f32 v17, v17, v47
  s_nop 1
  v_add_f32_dpp v17, v17, v17 row_ror:8 row_mask:0xf bank_mask:0xf
  s_nop 1
  v_add_f32_dpp v17, v17, v17 row_ror:4 row_mask:0xf bank_mask:0xf
  s_nop 1
  v_add_f32_dpp v17, v17, v17 row_ror:2 row_mask:0xf bank_mask:0xf
  s_nop 1
  v_add_f32_dpp v17, v17, v17 row_ror:1 row_mask:0xf bank_mask:0xf
  v_mov_b32 v18, v17
  s_nop 1
  v_permlane32_swap_b32 v17, v18
  v_add_f32 v17, v17, v18
  v_cvt_pk_bf16_f32 v32, v32, v61
  v_cvt_pk_bf16_f32 v33, v33, v61
  v_cvt_pk_bf16_f32 v34, v34, v61
  v_cvt_pk_bf16_f32 v35, v35, v61
  v_cvt_pk_bf16_f32 v36, v36, v61
  v_cvt_pk_bf16_f32 v37, v37, v61
  v_cvt_pk_bf16_f32 v38, v38, v61
  v_cvt_pk_bf16_f32 v39, v39, v61
  v_cvt_pk_bf16_f32 v40, v40, v61
  v_cvt_pk_bf16_f32 v41, v41, v61
  v_cvt_pk_bf16_f32 v42, v42, v61
  v_cvt_pk_bf16_f32 v43, v43, v61
  v_cvt_pk_bf16_f32 v44, v44, v61
  v_cvt_pk_bf16_f32 v45, v45, v61
  v_cvt_pk_bf16_f32 v46, v46, v61
  v_cvt_pk_bf16_f32 v47, v47, v61
  ds_write_b32 v2, v32 offset:0
  ds_write_b32 v2, v33 offset:256
  ds_write_b32 v2, v34 offset:512
  ds_write_b32 v2, v35 offset:768
  ds_write_b32 v2, v36 offset:1024
  ds_write_b32 v2, v37 offset:1280
  ds_write_b32 v2, v38 offset:1536
  ds_write_b32 v2, v39 offset:1792
  ds_write_b32 v2, v40 offset:2048
  ds_write_b32 v2, v41 offset:2304
  ds_write_b32 v2, v42 offset:2560
  ds_write_b32 v2, v43 offset:2816
  ds_write_b32 v2, v44 offset:3072
  ds_write_b32 v2, v45 offset:3328
  ds_write_b32 v2, v46 offset:3584
  ds_write_b32 v2, v47 offset:3840
  s_lshl_b32 s35, s26, 3
  v_mov_b32 v3, s35
  s_mov_b64 exec, 1
  ds_write_b64 v3, v[16:17] offset:64
  s_waitcnt lgkmcnt(0)
  ds_add_u32 v61, v62 offset:12
  s_mov_b64 exec, -1
  ds_read_b32 v32, v2 offset:0
  ds_read_b32 v34, v2 offset:256
  s_waitcnt lgkmcnt(0)
  v_lshlrev_b32 v33, 16, v32
  v_lshlrev_b32 v35, 16, v34
  s_waitcnt vmcnt(4)
  buffer_load_dwordx4 v[100:103], v1, s[44:47], s58 offen offset:1024 nt
  v_dot2c_f32_bf16_dpp v8, v32, v64 row_newbcast:0 row_mask:0xf bank_mask:0xf
  v_dot2c_f32_bf16_dpp v9, v33, v64 row_newbcast:0 row_mask:0xf bank_mask:0xf
  v_dot2c_f32_bf16_dpp v10, v32, v65 row_newbcast:0 row_mask:0xf bank_mask:0xf
  v_dot2c_f32_bf16_dpp v11, v33, v65 row_newbcast:0 row_mask:0xf bank_mask:0xf
  v_dot2c_f32_bf16_dpp v12, v32, v66 row_newbcast:0 row_mask:0xf bank_mask:0xf
  v_dot2c_f32_bf16_dpp v13, v33, v66 row_newbcast:0 row_mask:0xf bank_mask:0xf
  v_dot2c_f32_bf16_dpp v14, v32, v67 row_newbcast:0 row_mask:0xf bank_mask:0xf
  v_dot2c_f32_bf16_dpp v15, v33, v67 row_newbcast:0 row_mask:0xf bank_mask:0xf
  v_dot2c_f32_bf16_dpp v8, v32, v68 row_newbcast:1 row_mask:0xf bank_mask:0xf
  v_dot2c_f32_bf16_dpp v9, v33, v68 row_newbcast:1 row_mask:0xf bank_mask:0xf
  v_dot2c_f32_bf16_dpp v10, v32, v69 row_newbcast:1 row_mask:0xf bank_mask:0xf
  v_dot2c_f32_bf16_dpp v11, v33, v69 row_newbcast:1 row_mask:0xf bank_mask:0xf
  v_dot2c_f32_bf16_dpp v12, v32, v70 row_newbcast:1 row_mask:0xf bank_mask:0xf
  v_dot2c_f32_bf16_dpp v13, v33, v70 row_newbcast:1 row_mask:0xf bank_mask:0xf
  v_dot2c_f32_bf16_dpp v14, v32, v71 row_newbcast:1 row_mask:0xf bank_mask:0xf
  v_dot2c_f32_bf16_dpp v15, v33, v71 row_newbcast:1 row_mask:0xf bank_mask:0xf
  s_waitcnt vmcnt(4)
  buffer_load_dwordx4 v[104:107], v1, s[44:47], s58 offen offset:2048 nt
  v_dot2c_f32_bf16_dpp v8, v32, v72 row_newbcast:2 row_mask:0xf bank_mask:0xf
  v_dot2c_f32_bf16_dpp v9, v33, v72 row_newbcast:2 row_mask:0xf bank_mask:0xf
  v_dot2c_f32_bf16_dpp v10, v32, v73 row_newbcast:2 row_mask:0xf bank_mask:0xf
  v_dot2c_f32_bf16_dpp v11, v33, v73 row_newbcast:2 row_mask:0xf bank_mask:0xf
  v_dot2c_f32_bf16_dpp v12, v32, v74 row_newbcast:2 row_mask:0xf bank_mask:0xf
  v_dot2c_f32_bf16_dpp v13, v33, v74 row_newbcast:2 row_mask:0xf bank_mask:0xf
  v_dot2c_f32_bf16_dpp v14, v32, v75 row_newbcast:2 row_mask:0xf bank_mask:0xf
  v_dot2c_f32_bf16_dpp v15, v33, v75 row_newbcast:2 row_mask:0xf bank_mask:0xf
  v_dot2c_f32_bf16_dpp v8, v32, v76 row_newbcast:3 row_mask:0xf bank_mask:0xf
  v_dot2c_f32_bf16_dpp v9, v33, v76 row_newbcast:3 row_mask:0xf bank_mask:0xf
  v_dot2c_f32_bf16_dpp v10, v32, v77 row_newbcast:3 row_mask:0xf bank_mask:0xf
  v_dot2c_f32_bf16_dpp v11, v33, v77 row_newbcast:3 row_mask:0xf bank_mask:0xf
  v_dot2c_f32_bf16_dpp v12, v32, v78 row_newbcast:3 row_mask:0xf bank_mask:0xf
  v_dot2c_f32_bf16_dpp v13, v33, v78 row_newbcast:3 row_mask:0xf bank_mask:0xf
  v_dot2c_f32_bf16_dpp v14, v32, v79 row_newbcast:3 row_mask:0xf bank_mask:0xf
  v_dot2c_f32_bf16_dpp v15, v33, v79 row_newbcast:3 row_mask:0xf bank_mask:0xf
  s_waitcnt vmcnt(4)
  buffer_load_dwordx4 v[108:111], v1, s[44:47], s58 offen offset:3072 nt
  v_dot2c_f32_bf16_dpp v8, v32, v80 row_newbcast:4 row_mask:0xf bank_mask:0xf
  v_dot2c_f32_bf16_dpp v9, v33, v80 row_newbcast:4 row_mask:0xf bank_mask:0xf
  v_dot2c_f32_bf16_dpp v10, v32, v81 row_newbcast:4 row_mask:0xf bank_mask:0xf
  v_dot2c_f32_bf16_dpp v11, v33, v81 row_newbcast:4 row_mask:0xf bank_mask:0xf
  v_dot2c_f32_bf16_dpp v12, v32, v82 row_newbcast:4 row_mask:0xf bank_mask:0xf
  v_dot2c_f32_bf16_dpp v13, v33, v82 row_newbcast:4 row_mask:0xf bank_mask:0xf
  v_dot2c_f32_bf16_dpp v14, v32, v83 row_newbcast:4 row_mask:0xf bank_mask:0xf
  v_dot2c_f32_bf16_dpp v15, v33, v83 row_newbcast:4 row_mask:0xf bank_mask:0xf
  v_dot2c_f32_bf16_dpp v8, v32, v84 row_newbcast:5 row_mask:0xf bank_mask:0xf
  v_dot2c_f32_bf16_dpp v9, v33, v84 row_newbcast:5 row_mask:0xf bank_mask:0xf
  v_dot2c_f32_bf16_dpp v10, v32, v85 row_newbcast:5 row_mask:0xf bank_mask:0xf
  v_dot2c_f32_bf16_dpp v11, v33, v85 row_newbcast:5 row_mask:0xf bank_mask:0xf
  v_dot2c_f32_bf16_dpp v12, v32, v86 row_newbcast:5 row_mask:0xf bank_mask:0xf
  v_dot2c_f32_bf16_dpp v13, v33, v86 row_newbcast:5 row_mask:0xf bank_mask:0xf
  v_dot2c_f32_bf16_dpp v14, v32, v87 row_newbcast:5 row_mask:0xf bank_mask:0xf
  v_dot2c_f32_bf16_dpp v15, v33, v87 row_newbcast:5 row_mask:0xf bank_mask:0xf
  s_waitcnt vmcnt(4)
  buffer_load_dwordx4 v[112:115], v1, s[44:47], s59 offen offset:0 nt
  v_dot2c_f32_bf16_dpp v8, v32, v88 row_newbcast:6 row_mask:0xf bank_mask:0xf
  v_dot2c_f32_bf16_dpp v9, v33, v88 row_newbcast:6 row_mask:0xf bank_mask:0xf
  v_dot2c_f32_bf16_dpp v10, v32, v89 row_newbcast:6 row_mask:0xf bank_mask:0xf
  v_dot2c_f32_bf16_dpp v11, v33, v89 row_newbcast:6 row_mask:0xf bank_mask:0xf
  v_dot2c_f32_bf16_dpp v12, v32, v90 row_newbcast:6 row_mask:0xf bank_mask:0xf
  v_dot2c_f32_bf16_dpp v13, v33, v90 row_newbcast:6 row_mask:0xf bank_mask:0xf
  v_dot2c_f32_bf16_dpp v14, v32, v91 row_newbcast:6 row_mask:0xf bank_mask:0xf
  v_dot2c_f32_bf16_dpp v15, v33, v91 row_newbcast:6 row_mask:0xf bank_mask:0xf
  s_waitcnt vmcnt(4)
  buffer_load_dwordx4 v[116:119], v1, s[44:47], s59 offen offset:1024 nt
  v_dot2c_f32_bf16_dpp v8, v32, v92 row_newbcast:7 row_mask:0xf bank_mask:0xf
  v_dot2c_f32_bf16_dpp v9, v33, v92 row_newbcast:7 row_mask:0xf bank_mask:0xf
  v_dot2c_f32_bf16_dpp v10, v32, v93 row_newbcast:7 row_mask:0xf bank_mask:0xf
  v_dot2c_f32_bf16_dpp v11, v33, v93 row_newbcast:7 row_mask:0xf bank_mask:0xf
  v_dot2c_f32_bf16_dpp v12, v32, v94 row_newbcast:7 row_mask:0xf bank_mask:0xf
  v_dot2c_f32_bf16_dpp v13, v33, v94 row_newbcast:7 row_mask:0xf bank_mask:0xf
  v_dot2c_f32_bf16_dpp v14, v32, v95 row_newbcast:7 row_mask:0xf bank_mask:0xf
  v_dot2c_f32_bf16_dpp v15, v33, v95 row_newbcast:7 row_mask:0xf bank_mask:0xf
  s_waitcnt vmcnt(4)
  buffer_load_dwordx4 v[120:123], v1, s[44:47], s59 offen offset:2048 nt
  v_dot2c_f32_bf16_dpp v8, v32, v96 row_newbcast:8 row_mask:0xf bank_mask:0xf
  v_dot2c_f32_bf16_dpp v9, v33, v96 row_newbcast:8 row_mask:0xf bank_mask:0xf
  v_dot2c_f32_bf16_dpp v10, v32, v97 row_newbcast:8 row_mask:0xf bank_mask:0xf
  v_dot2c_f32_bf16_dpp v11, v33, v97 row_newbcast:8 row_mask:0xf bank_mask:0xf
  v_dot2c_f32_bf16_dpp v12, v32, v98 row_newbcast:8 row_mask:0xf bank_mask:0xf
  v_dot2c_f32_bf16_dpp v13, v33, v98 row_newbcast:8 row_mask:0xf bank_mask:0xf
  v_dot2c_f32_bf16_dpp v14, v32, v99 row_newbcast:8 row_mask:0xf bank_mask:0xf
  v_dot2c_f32_bf16_dpp v15, v33, v99 row_newbcast:8 row_mask:0xf bank_mask:0xf
  s_waitcnt vmcnt(4)
  buffer_load_dwordx4 v[124:127], v1, s[44:47], s59 offen offset:3072 nt
  v_dot2c_f32_bf16_dpp v8, v32, v100 row_newbcast:9 row_mask:0xf bank_mask:0xf
  v_dot2c_f32_bf16_dpp v9, v33, v100 row_newbcast:9 row_mask:0xf bank_mask:0xf
  v_dot2c_f32_bf16_dpp v10, v32, v101 row_newbcast:9 row_mask:0xf bank_mask:0xf
  v_dot2c_f32_bf16_dpp v11, v33, v101 row_newbcast:9 row_mask:0xf bank_mask:0xf
  v_dot2c_f32_bf16_dpp v12, v32, v102 row_newbcast:9 row_mask:0xf bank_mask:0xf
  v_dot2c_f32_bf16_dpp v13, v33, v102 row_newbcast:9 row_mask:0xf bank_mask:0xf
  v_dot2c_f32_bf16_dpp v14, v32, v103 row_newbcast:9 row_mask:0xf bank_mask:0xf
  v_dot2c_f32_bf16_dpp v15, v33, v103 row_newbcast:9 row_mask:0xf bank_mask:0xf
  s_waitcnt vmcnt(4)
  buffer_load_dwordx4 v[128:131], v1, s[44:47], s60 offen offset:0 nt
  v_dot2c_f32_bf16_dpp v8, v32, v104 row_newbcast:10 row_mask:0xf bank_mask:0xf
  v_dot2c_f32_bf16_dpp v9, v33, v104 row_newbcast:10 row_mask:0xf bank_mask:0xf
  v_dot2c_f32_bf16_dpp v10, v32, v105 row_newbcast:10 row_mask:0xf bank_mask:0xf
  v_dot2c_f32_bf16_dpp v11, v33, v105 row_newbcast:10 row_mask:0xf bank_mask:0xf
  v_dot2c_f32_bf16_dpp v12, v32, v106 row_newbcast:10 row_mask:0xf bank_mask:0xf
  v_dot2c_f32_bf16_dpp v13, v33, v106 row_newbcast:10 row_mask:0xf bank_mask:0xf
  v_dot2c_f32_bf16_dpp v14, v32, v107 row_newbcast:10 row_mask:0xf bank_mask:0xf
  v_dot2c_f32_bf16_dpp v15, v33, v107 row_newbcast:10 row_mask:0xf bank_mask:0xf
  s_waitcnt vmcnt(4)
  buffer_load_dwordx4 v[132:135], v1, s[44:47], s60 offen offset:1024 nt
  v_dot2c_f32_bf16_dpp v8, v32, v108 row_newbcast:11 row_mask:0xf bank_mask:0xf
  v_dot2c_f32_bf16_dpp v9, v33, v108 row_newbcast:11 row_mask:0xf bank_mask:0xf
  v_dot2c_f32_bf16_dpp v10, v32, v109 row_newbcast:11 row_mask:0xf bank_mask:0xf
  v_dot2c_f32_bf16_dpp v11, v33, v109 row_newbcast:11 row_mask:0xf bank_mask:0xf
  v_dot2c_f32_bf16_dpp v12, v32, v110 row_newbcast:11 row_mask:0xf bank_mask:0xf
  v_dot2c_f32_bf16_dpp v13, v33, v110 row_newbcast:11 row_mask:0xf bank_mask:0xf
  v_dot2c_f32_bf16_dpp v14, v32, v111 row_newbcast:11 row_mask:0xf bank_mask:0xf
  v_dot2c_f32_bf16_dpp v15, v33, v111 row_newbcast:11 row_mask:0xf bank_mask:0xf
  s_waitcnt vmcnt(4)
  buffer_load_dwordx4 v[136:139], v1, s[44:47], s60 offen offset:2048 nt
  v_dot2c_f32_bf16_dpp v8, v32, v112 row_newbcast:12 row_mask:0xf bank_mask:0xf
  v_dot2c_f32_bf16_dpp v9, v33, v112 row_newbcast:12 row_mask:0xf bank_mask:0xf
  v_dot2c_f32_bf16_dpp v10, v32, v113 row_newbcast:12 row_mask:0xf bank_mask:0xf
  v_dot2c_f32_bf16_dpp v11, v33, v113 row_newbcast:12 row_mask:0xf bank_mask:0xf
  v_dot2c_f32_bf16_dpp v12, v32, v114 row_newbcast:12 row_mask:0xf bank_mask:0xf
  v_dot2c_f32_bf16_dpp v13, v33, v114 row_newbcast:12 row_mask:0xf bank_mask:0xf
  v_dot2c_f32_bf16_dpp v14, v32, v115 row_newbcast:12 row_mask:0xf bank_mask:0xf
  v_dot2c_f32_bf16_dpp v15, v33, v115 row_newbcast:12 row_mask:0xf bank_mask:0xf
  s_waitcnt vmcnt(4)
  buffer_load_dwordx4 v[140:143], v1, s[44:47], s60 offen offset:3072 nt
  v_dot2c_f32_bf16_dpp v8, v32, v116 row_newbcast:13 row_mask:0xf bank_mask:0xf
  v_dot2c_f32_bf16_dpp v9, v33, v116 row_newbcast:13 row_mask:0xf bank_mask:0xf
  v_dot2c_f32_bf16_dpp v10, v32, v117 row_newbcast:13 row_mask:0xf bank_mask:0xf
  v_dot2c_f32_bf16_dpp v11, v33, v117 row_newbcast:13 row_mask:0xf bank_mask:0xf
  v_dot2c_f32_bf16_dpp v12, v32, v118 row_newbcast:13 row_mask:0xf bank_mask:0xf
  v_dot2c_f32_bf16_dpp v13, v33, v118 row_newbcast:13 row_mask:0xf bank_mask:0xf
  v_dot2c_f32_bf16_dpp v14, v32, v119 row_newbcast:13 row_mask:0xf bank_mask:0xf
  v_dot2c_f32_bf16_dpp v15, v33, v119 row_newbcast:13 row_mask:0xf bank_mask:0xf
  s_waitcnt vmcnt(4)
  buffer_load_dwordx4 v[144:147], v1, s[44:47], s61 offen offset:0 nt
  v_dot2c_f32_bf16_dpp v8, v32, v120 row_newbcast:14 row_mask:0xf bank_mask:0xf
  v_dot2c_f32_bf16_dpp v9, v33, v120 row_newbcast:14 row_mask:0xf bank_mask:0xf
  v_dot2c_f32_bf16_dpp v10, v32, v121 row_newbcast:14 row_mask:0xf bank_mask:0xf
  v_dot2c_f32_bf16_dpp v11, v33, v121 row_newbcast:14 row_mask:0xf bank_mask:0xf
  v_dot2c_f32_bf16_dpp v12, v32, v122 row_newbcast:14 row_mask:0xf bank_mask:0xf
  v_dot2c_f32_bf16_dpp v13, v33, v122 row_newbcast:14 row_mask:0xf bank_mask:0xf
  v_dot2c_f32_bf16_dpp v14, v32, v123 row_newbcast:14 row_mask:0xf bank_mask:0xf
  v_dot2c_f32_bf16_dpp v15, v33, v123 row_newbcast:14 row_mask:0xf bank_mask:0xf
  s_waitcnt vmcnt(4)
  buffer_load_dwordx4 v[148:151], v1, s[44:47], s61 offen offset:1024 nt
  v_dot2c_f32_bf16_dpp v8, v32, v124 row_newbcast:15 row_mask:0xf bank_mask:0xf
  v_dot2c_f32_bf16_dpp v9, v33, v124 row_newbcast:15 row_mask:0xf bank_mask:0xf
  v_dot2c_f32_bf16_dpp v10, v32, v125 row_newbcast:15 row_mask:0xf bank_mask:0xf
  v_dot2c_f32_bf16_dpp v11, v33, v125 row_newbcast:15 row_mask:0xf bank_mask:0xf
  v_dot2c_f32_bf16_dpp v12, v32, v126 row_newbcast:15 row_mask:0xf bank_mask:0xf
  v_dot2c_f32_bf16_dpp v13, v33, v126 row_newbcast:15 row_mask:0xf bank_mask:0xf
  v_dot2c_f32_bf16_dpp v14, v32, v127 row_newbcast:15 row_mask:0xf bank_mask:0xf
  v_dot2c_f32_bf16_dpp v15, v33, v127 row_newbcast:15 row_mask:0xf bank_mask:0xf
  s_waitcnt vmcnt(4)
  buffer_load_dwordx4 v[152:155], v1, s[44:47], s61 offen offset:2048 nt
  v_dot2c_f32_bf16_dpp v8, v34, v128 row_newbcast:0 row_mask:0xf bank_mask:0xf
  v_dot2c_f32_bf16_dpp v9, v35, v128 row_newbcast:0 row_mask:0xf bank_mask:0xf
  v_dot2c_f32_bf16_dpp v10, v34, v129 row_newbcast:0 row_mask:0xf bank_mask:0xf
  v_dot2c_f32_bf16_dpp v11, v35, v129 row_newbcast:0 row_mask:0xf bank_mask:0xf
  v_dot2c_f32_bf16_dpp v12, v34, v130 row_newbcast:0 row_mask:0xf bank_mask:0xf
  v_dot2c_f32_bf16_dpp v13, v35, v130 row_newbcast:0 row_mask:0xf bank_mask:0xf
  v_dot2c_f32_bf16_dpp v14, v34, v131 row_newbcast:0 row_mask:0xf bank_mask:0xf
  v_dot2c_f32_bf16_dpp v15, v35, v131 row_newbcast:0 row_mask:0xf bank_mask:0xf
  s_waitcnt vmcnt(4)
  buffer_load_dwordx4 v[156:159], v1, s[44:47], s61 offen offset:3072 nt
  v_dot2c_f32_bf16_dpp v8, v34, v132 row_newbcast:1 row_mask:0xf bank_mask:0xf
  v_dot2c_f32_bf16_dpp v9, v35, v132 row_newbcast:1 row_mask:0xf bank_mask:0xf
  v_dot2c_f32_bf16_dpp v10, v34, v133 row_newbcast:1 row_mask:0xf bank_mask:0xf
  v_dot2c_f32_bf16_dpp v11, v35, v133 row_newbcast:1 row_mask:0xf bank_mask:0xf
  v_dot2c_f32_bf16_dpp v12, v34, v134 row_newbcast:1 row_mask:0xf bank_mask:0xf
  v_dot2c_f32_bf16_dpp v13, v35, v134 row_newbcast:1 row_mask:0xf bank_mask:0xf
  v_dot2c_f32_bf16_dpp v14, v34, v135 row_newbcast:1 row_mask:0xf bank_mask:0xf
  v_dot2c_f32_bf16_dpp v15, v35, v135 row_newbcast:1 row_mask:0xf bank_mask:0xf
  s_waitcnt vmcnt(4)
  buffer_load_dwordx4 v[160:163], v1, s[44:47], s62 offen offset:0 nt
  v_dot2c_f32_bf16_dpp v8, v34, v136 row_newbcast:2 row_mask:0xf bank_mask:0xf
  v_dot2c_f32_bf16_dpp v9, v35, v136 row_newbcast:2 row_mask:0xf bank_mask:0xf
  v_dot2c_f32_bf16_dpp v10, v34, v137 row_newbcast:2 row_mask:0xf bank_mask:0xf
  v_dot2c_f32_bf16_dpp v11, v35, v137 row_newbcast:2 row_mask:0xf bank_mask:0xf
  v_dot2c_f32_bf16_dpp v12, v34, v138 row_newbcast:2 row_mask:0xf bank_mask:0xf
  v_dot2c_f32_bf16_dpp v13, v35, v138 row_newbcast:2 row_mask:0xf bank_mask:0xf
  v_dot2c_f32_bf16_dpp v14, v34, v139 row_newbcast:2 row_mask:0xf bank_mask:0xf
  v_dot2c_f32_bf16_dpp v15, v35, v139 row_newbcast:2 row_mask:0xf bank_mask:0xf
  s_waitcnt vmcnt(4)
  buffer_load_dwordx4 v[164:167], v1, s[44:47], s62 offen offset:1024 nt
  v_dot2c_f32_bf16_dpp v8, v34, v140 row_newbcast:3 row_mask:0xf bank_mask:0xf
  v_dot2c_f32_bf16_dpp v9, v35, v140 row_newbcast:3 row_mask:0xf bank_mask:0xf
  v_dot2c_f32_bf16_dpp v10, v34, v141 row_newbcast:3 row_mask:0xf bank_mask:0xf
  v_dot2c_f32_bf16_dpp v11, v35, v141 row_newbcast:3 row_mask:0xf bank_mask:0xf
  v_dot2c_f32_bf16_dpp v12, v34, v142 row_newbcast:3 row_mask:0xf bank_mask:0xf
  v_dot2c_f32_bf16_dpp v13, v35, v142 row_newbcast:3 row_mask:0xf bank_mask:0xf
  v_dot2c_f32_bf16_dpp v14, v34, v143 row_newbcast:3 row_mask:0xf bank_mask:0xf
  v_dot2c_f32_bf16_dpp v15, v35, v143 row_newbcast:3 row_mask:0xf bank_mask:0xf
  s_waitcnt vmcnt(4)
  buffer_load_dwordx4 v[168:171], v1, s[44:47], s62 offen offset:2048 nt
  v_dot2c_f32_bf16_dpp v8, v34, v144 row_newbcast:4 row_mask:0xf bank_mask:0xf
  v_dot2c_f32_bf16_dpp v9, v35, v144 row_newbcast:4 row_mask:0xf bank_mask:0xf
  v_dot2c_f32_bf16_dpp v10, v34, v145 row_newbcast:4 row_mask:0xf bank_mask:0xf
  v_dot2c_f32_bf16_dpp v11, v35, v145 row_newbcast:4 row_mask:0xf bank_mask:0xf
  v_dot2c_f32_bf16_dpp v12, v34, v146 row_newbcast:4 row_mask:0xf bank_mask:0xf
  v_dot2c_f32_bf16_dpp v13, v35, v146 row_newbcast:4 row_mask:0xf bank_mask:0xf
  v_dot2c_f32_bf16_dpp v14, v34, v147 row_newbcast:4 row_mask:0xf bank_mask:0xf
  v_dot2c_f32_bf16_dpp v15, v35, v147 row_newbcast:4 row_mask:0xf bank_mask:0xf
  s_waitcnt vmcnt(4)
  buffer_load_dwordx4 v[172:175], v1, s[44:47], s62 offen offset:3072 nt
  v_dot2c_f32_bf16_dpp v8, v34, v148 row_newbcast:5 row_mask:0xf bank_mask:0xf
  v_dot2c_f32_bf16_dpp v9, v35, v148 row_newbcast:5 row_mask:0xf bank_mask:0xf
  v_dot2c_f32_bf16_dpp v10, v34, v149 row_newbcast:5 row_mask:0xf bank_mask:0xf
  v_dot2c_f32_bf16_dpp v11, v35, v149 row_newbcast:5 row_mask:0xf bank_mask:0xf
  v_dot2c_f32_bf16_dpp v12, v34, v150 row_newbcast:5 row_mask:0xf bank_mask:0xf
  v_dot2c_f32_bf16_dpp v13, v35, v150 row_newbcast:5 row_mask:0xf bank_mask:0xf
  v_dot2c_f32_bf16_dpp v14, v34, v151 row_newbcast:5 row_mask:0xf bank_mask:0xf
  v_dot2c_f32_bf16_dpp v15, v35, v151 row_newbcast:5 row_mask:0xf bank_mask:0xf
  s_waitcnt vmcnt(4)
  buffer_load_dwordx4 v[176:179], v1, s[44:47], s63 offen offset:0 nt
  v_dot2c_f32_bf16_dpp v8, v34, v152 row_newbcast:6 row_mask:0xf bank_mask:0xf
  v_dot2c_f32_bf16_dpp v9, v35, v152 row_newbcast:6 row_mask:0xf bank_mask:0xf
  v_dot2c_f32_bf16_dpp v10, v34, v153 row_newbcast:6 row_mask:0xf bank_mask:0xf
  v_dot2c_f32_bf16_dpp v11, v35, v153 row_newbcast:6 row_mask:0xf bank_mask:0xf
  v_dot2c_f32_bf16_dpp v12, v34, v154 row_newbcast:6 row_mask:0xf bank_mask:0xf
  v_dot2c_f32_bf16_dpp v13, v35, v154 row_newbcast:6 row_mask:0xf bank_mask:0xf
  v_dot2c_f32_bf16_dpp v14, v34, v155 row_newbcast:6 row_mask:0xf bank_mask:0xf
  v_dot2c_f32_bf16_dpp v15, v35, v155 row_newbcast:6 row_mask:0xf bank_mask:0xf
  s_waitcnt vmcnt(4)
  buffer_load_dwordx4 v[180:183], v1, s[44:47], s63 offen offset:1024 nt
  v_dot2c_f32_bf16_dpp v8, v34, v156 row_newbcast:7 row_mask:0xf bank_mask:0xf
  v_dot2c_f32_bf16_dpp v9, v35, v156 row_newbcast:7 row_mask:0xf bank_mask:0xf
  v_dot2c_f32_bf16_dpp v10, v34, v157 row_newbcast:7 row_mask:0xf bank_mask:0xf
  v_dot2c_f32_bf16_dpp v11, v35, v157 row_newbcast:7 row_mask:0xf bank_mask:0xf
  v_dot2c_f32_bf16_dpp v12, v34, v158 row_newbcast:7 row_mask:0xf bank_mask:0xf
  v_dot2c_f32_bf16_dpp v13, v35, v158 row_newbcast:7 row_mask:0xf bank_mask:0xf
  v_dot2c_f32_bf16_dpp v14, v34, v159 row_newbcast:7 row_mask:0xf bank_mask:0xf
  v_dot2c_f32_bf16_dpp v15, v35, v159 row_newbcast:7 row_mask:0xf bank_mask:0xf
  s_waitcnt vmcnt(4)
  buffer_load_dwordx4 v[184:187], v1, s[44:47], s63 offen offset:2048 nt
  v_dot2c_f32_bf16_dpp v8, v34, v160 row_newbcast:8 row_mask:0xf bank_mask:0xf
  v_dot2c_f32_bf16_dpp v9, v35, v160 row_newbcast:8 row_mask:0xf bank_mask:0xf
  v_dot2c_f32_bf16_dpp v10, v34, v161 row_newbcast:8 row_mask:0xf bank_mask:0xf
  v_dot2c_f32_bf16_dpp v11, v35, v161 row_newbcast:8 row_mask:0xf bank_mask:0xf
  v_dot2c_f32_bf16_dpp v12, v34, v162 row_newbcast:8 row_mask:0xf bank_mask:0xf
  v_dot2c_f32_bf16_dpp v13, v35, v162 row_newbcast:8 row_mask:0xf bank_mask:0xf
  v_dot2c_f32_bf16_dpp v14, v34, v163 row_newbcast:8 row_mask:0xf bank_mask:0xf
  v_dot2c_f32_bf16_dpp v15, v35, v163 row_newbcast:8 row_mask:0xf bank_mask:0xf
  s_waitcnt vmcnt(4)
  buffer_load_dwordx4 v[188:191], v1, s[44:47], s63 offen offset:3072 nt
  v_dot2c_f32_bf16_dpp v8, v34, v164 row_newbcast:9 row_mask:0xf bank_mask:0xf
  v_dot2c_f32_bf16_dpp v9, v35, v164 row_newbcast:9 row_mask:0xf bank_mask:0xf
  v_dot2c_f32_bf16_dpp v10, v34, v165 row_newbcast:9 row_mask:0xf bank_mask:0xf
  v_dot2c_f32_bf16_dpp v11, v35, v165 row_newbcast:9 row_mask:0xf bank_mask:0xf
  v_dot2c_f32_bf16_dpp v12, v34, v166 row_newbcast:9 row_mask:0xf bank_mask:0xf
  v_dot2c_f32_bf16_dpp v13, v35, v166 row_newbcast:9 row_mask:0xf bank_mask:0xf
  v_dot2c_f32_bf16_dpp v14, v34, v167 row_newbcast:9 row_mask:0xf bank_mask:0xf
  v_dot2c_f32_bf16_dpp v15, v35, v167 row_newbcast:9 row_mask:0xf bank_mask:0xf
  s_waitcnt vmcnt(4)
  buffer_load_dwordx4 v[64:67], v1, s[48:51], s56 offen offset:0 nt
  v_dot2c_f32_bf16_dpp v8, v34, v168 row_newbcast:10 row_mask:0xf bank_mask:0xf
  v_dot2c_f32_bf16_dpp v9, v35, v168 row_newbcast:10 row_mask:0xf bank_mask:0xf
  v_dot2c_f32_bf16_dpp v10, v34, v169 row_newbcast:10 row_mask:0xf bank_mask:0xf
  v_dot2c_f32_bf16_dpp v11, v35, v169 row_newbcast:10 row_mask:0xf bank_mask:0xf
  v_dot2c_f32_bf16_dpp v12, v34, v170 row_newbcast:10 row_mask:0xf bank_mask:0xf
  v_dot2c_f32_bf16_dpp v13, v35, v170 row_newbcast:10 row_mask:0xf bank_mask:0xf
  v_dot2c_f32_bf16_dpp v14, v34, v171 row_newbcast:10 row_mask:0xf bank_mask:0xf
  v_dot2c_f32_bf16_dpp v15, v35, v171 row_newbcast:10 row_mask:0xf bank_mask:0xf
  s_waitcnt vmcnt(4)
  buffer_load_dwordx4 v[68:71], v1, s[48:51], s56 offen offset:1024 nt
  v_dot2c_f32_bf16_dpp v8, v34, v172 row_newbcast:11 row_mask:0xf bank_mask:0xf
  v_dot2c_f32_bf16_dpp v9, v35, v172 row_newbcast:11 row_mask:0xf bank_mask:0xf
  v_dot2c_f32_bf16_dpp v10, v34, v173 row_newbcast:11 row_mask:0xf bank_mask:0xf
  v_dot2c_f32_bf16_dpp v11, v35, v173 row_newbcast:11 row_mask:0xf bank_mask:0xf
  v_dot2c_f32_bf16_dpp v12, v34, v174 row_newbcast:11 row_mask:0xf bank_mask:0xf
  v_dot2c_f32_bf16_dpp v13, v35, v174 row_newbcast:11 row_mask:0xf bank_mask:0xf
  v_dot2c_f32_bf16_dpp v14, v34, v175 row_newbcast:11 row_mask:0xf bank_mask:0xf
  v_dot2c_f32_bf16_dpp v15, v35, v175 row_newbcast:11 row_mask:0xf bank_mask:0xf
  s_waitcnt vmcnt(4)
  buffer_load_dwordx4 v[72:75], v1, s[48:51], s56 offen offset:2048 nt
  v_dot2c_f32_bf16_dpp v8, v34, v176 row_newbcast:12 row_mask:0xf bank_mask:0xf
  v_dot2c_f32_bf16_dpp v9, v35, v176 row_newbcast:12 row_mask:0xf bank_mask:0xf
  v_dot2c_f32_bf16_dpp v10, v34, v177 row_newbcast:12 row_mask:0xf bank_mask:0xf
  v_dot2c_f32_bf16_dpp v11, v35, v177 row_newbcast:12 row_mask:0xf bank_mask:0xf
  v_dot2c_f32_bf16_dpp v12, v34, v178 row_newbcast:12 row_mask:0xf bank_mask:0xf
  v_dot2c_f32_bf16_dpp v13, v35, v178 row_newbcast:12 row_mask:0xf bank_mask:0xf
  v_dot2c_f32_bf16_dpp v14, v34, v179 row_newbcast:12 row_mask:0xf bank_mask:0xf
  v_dot2c_f32_bf16_dpp v15, v35, v179 row_newbcast:12 row_mask:0xf bank_mask:0xf
  s_waitcnt vmcnt(4)
  buffer_load_dwordx4 v[76:79], v1, s[48:51], s56 offen offset:3072 nt
  v_dot2c_f32_bf16_dpp v8, v34, v180 row_newbcast:13 row_mask:0xf bank_mask:0xf
  v_dot2c_f32_bf16_dpp v9, v35, v180 row_newbcast:13 row_mask:0xf bank_mask:0xf
  v_dot2c_f32_bf16_dpp v10, v34, v181 row_newbcast:13 row_mask:0xf bank_mask:0xf
  v_dot2c_f32_bf16_dpp v11, v35, v181 row_newbcast:13 row_mask:0xf bank_mask:0xf
  v_dot2c_f32_bf16_dpp v12, v34, v182 row_newbcast:13 row_mask:0xf bank_mask:0xf
  v_dot2c_f32_bf16_dpp v13, v35, v182 row_newbcast:13 row_mask:0xf bank_mask:0xf
  v_dot2c_f32_bf16_dpp v14, v34, v183 row_newbcast:13 row_mask:0xf bank_mask:0xf
  v_dot2c_f32_bf16_dpp v15, v35, v183 row_newbcast:13 row_mask:0xf bank_mask:0xf
  s_waitcnt vmcnt(4)
  buffer_load_dwordx4 v[80:83], v1, s[48:51], s57 offen offset:0 nt
  v_dot2c_f32_bf16_dpp v8, v34, v184 row_newbcast:14 row_mask:0xf bank_mask:0xf
  v_dot2c_f32_bf16_dpp v9, v35, v184 row_newbcast:14 row_mask:0xf bank_mask:0xf
  v_dot2c_f32_bf16_dpp v10, v34, v185 row_newbcast:14 row_mask:0xf bank_mask:0xf
  v_dot2c_f32_bf16_dpp v11, v35, v185 row_newbcast:14 row_mask:0xf bank_mask:0xf
  v_dot2c_f32_bf16_dpp v12, v34, v186 row_newbcast:14 row_mask:0xf bank_mask:0xf
  v_dot2c_f32_bf16_dpp v13, v35, v186 row_newbcast:14 row_mask:0xf bank_mask:0xf
  v_dot2c_f32_bf16_dpp v14, v34, v187 row_newbcast:14 row_mask:0xf bank_mask:0xf
  v_dot2c_f32_bf16_dpp v15, v35, v187 row_newbcast:14 row_mask:0xf bank_mask:0xf
  s_waitcnt vmcnt(4)
  buffer_load_dwordx4 v[84:87], v1, s[48:51], s57 offen offset:1024 nt
  v_dot2c_f32_bf16_dpp v8, v34, v188 row_newbcast:15 row_mask:0xf bank_mask:0xf
  v_dot2c_f32_bf16_dpp v9, v35, v188 row_newbcast:15 row_mask:0xf bank_mask:0xf
  v_dot2c_f32_bf16_dpp v10, v34, v189 row_newbcast:15 row_mask:0xf bank_mask:0xf
  v_dot2c_f32_bf16_dpp v11, v35, v189 row_newbcast:15 row_mask:0xf bank_mask:0xf
  v_dot2c_f32_bf16_dpp v12, v34, v190 row_newbcast:15 row_mask:0xf bank_mask:0xf
  v_dot2c_f32_bf16_dpp v13, v35, v190 row_newbcast:15 row_mask:0xf bank_mask:0xf
  v_dot2c_f32_bf16_dpp v14, v34, v191 row_newbcast:15 row_mask:0xf bank_mask:0xf
  v_dot2c_f32_bf16_dpp v15, v35, v191 row_newbcast:15 row_mask:0xf bank_mask:0xf
  s_mov_b32 s44, s48
  s_mov_b32 s45, s49
  s_add_u32 s48, s48, 131072
  s_addc_u32 s49, s49, 0
  s_mov_b32 s34, 9
L_vloop:
  v_add_u32 v2, 512, v2
  s_waitcnt vmcnt(4)
  buffer_load_dwordx4 v[88:91], v1, s[44:47], s57 offen offset:2048 nt
  ds_read_b32 v32, v2 offset:0
  ds_read_b32 v34, v2 offset:256
  s_waitcnt lgkmcnt(0)
  v_lshlrev_b32 v33, 16, v32
  v_lshlrev_b32 v35, 16, v34
  v_dot2c_f32_bf16_dpp v8, v32, v64 row_newbcast:0 row_mask:0xf bank_mask:0xf
  v_dot2c_f32_bf16_dpp v9, v33, v64 row_newbcast:0 row_mask:0xf bank_mask:0xf
  v_dot2c_f32_bf16_dpp v10, v32, v65 row_newbcast:0 row_mask:0xf bank_mask:0xf
  v_dot2c_f32_bf16_dpp v11, v33, v65 row_newbcast:0 row_mask:0xf bank_mask:0xf
  v_dot2c_f32_bf16_dpp v12, v32, v66 row_newbcast:0 row_mask:0xf bank_mask:0xf
  v_dot2c_f32_bf16_dpp v13, v33, v66 row_newbcast:0 row_mask:0xf bank_mask:0xf
  v_dot2c_f32_bf16_dpp v14, v32, v67 row_newbcast:0 row_mask:0xf bank_mask:0xf
  v_dot2c_f32_bf16_dpp v15, v33, v67 row_newbcast:0 row_mask:0xf bank_mask:0xf
  s_waitcnt vmcnt(4)
  buffer_load_dwordx4 v[92:95], v1, s[44:47], s57 offen offset:3072 nt
  v_dot2c_f32_bf16_dpp v8, v32, v68 row_newbcast:1 row_mask:0xf bank_mask:0xf
  v_dot2c_f32_bf16_dpp v9, v33, v68 row_newbcast:1 row_mask:0xf bank_mask:0xf
  v_dot2c_f32_bf16_dpp v10, v32, v69 row_newbcast:1 row_mask:0xf bank_mask:0xf
  v_dot2c_f32_bf16_dpp v11, v33, v69 row_newbcast:1 row_mask:0xf bank_mask:0xf
  v_dot2c_f32_bf16_dpp v12, v32, v70 row_newbcast:1 row_mask:0xf bank_mask:0xf
  v_dot2c_f32_bf16_dpp v13, v33, v70 row_newbcast:1 row_mask:0xf bank_mask:0xf
  v_dot2c_f32_bf16_dpp v14, v32, v71 row_newbcast:1 row_mask:0xf bank_mask:0xf
  v_dot2c_f32_bf16_dpp v15, v33, v71 row_newbcast:1 row_mask:0xf bank_mask:0xf
  s_waitcnt vmcnt(4)
  buffer_load_dwordx4 v[96:99], v1, s[44:47], s58 offen offset:0 nt
  v_dot2c_f32_bf16_dpp v8, v32, v72 row_newbcast:2 row_mask:0xf bank_mask:0xf
  v_dot2c_f32_bf16_dpp v9, v33, v72 row_newbcast:2 row_mask:0xf bank_mask:0xf
  v_dot2c_f32_bf16_dpp v10, v32, v73 row_newbcast:2 row_mask:0xf bank_mask:0xf
  v_dot2c_f32_bf16_dpp v11, v33, v73 row_newbcast:2 row_mask:0xf bank_mask:0xf
  v_dot2c_f32_bf16_dpp v12, v32, v74 row_newbcast:2 row_mask:0xf bank_mask:0xf
  v_dot2c_f32_bf16_dpp v13, v33, v74 row_newbcast:2 row_mask:0xf bank_mask:0xf
  v_dot2c_f32_bf16_dpp v14, v32, v75 row_newbcast:2 row_mask:0xf bank_mask:0xf
  v_dot2c_f32_bf16_dpp v15, v33, v75 row_newbcast:2 row_mask:0xf bank_mask:0xf
  s_waitcnt vmcnt(4)
  buffer_load_dwordx4 v[100:103], v1, s[44:47], s58 offen offset:1024 nt
  v_dot2c_f32_bf16_dpp v8, v32, v76 row_newbcast:3 row_mask:0xf bank_mask:0xf
  v_dot2c_f32_bf16_dpp v9, v33, v76 row_newbcast:3 row_mask:0xf bank_mask:0xf
  v_dot2c_f32_bf16_dpp v10, v32, v77 row_newbcast:3 row_mask:0xf bank_mask:0xf
  v_dot2c_f32_bf16_dpp v11, v33, v77 row_newbcast:3 row_mask:0xf bank_mask:0xf
  v_dot2c_f32_bf16_dpp v12, v32, v78 row_newbcast:3 row_mask:0xf bank_mask:0xf
  v_dot2c_f32_bf16_dpp v13, v33, v78 row_newbcast:3 row_mask:0xf bank_mask:0xf
  v_dot2c_f32_bf16_dpp v14, v32, v79 row_newbcast:3 row_mask:0xf bank_mask:0xf
  v_dot2c_f32_bf16_dpp v15, v33, v79 row_newbcast:3 row_mask:0xf bank_mask:0xf
  s_waitcnt vmcnt(4)
  buffer_load_dwordx4 v[104:107], v1, s[44:47], s58 offen offset:2048 nt
  v_dot2c_f32_bf16_dpp v8, v32, v80 row_newbcast:4 row_mask:0xf bank_mask:0xf
  v_dot2c_f32_bf16_dpp v9, v33, v80 row_newbcast:4 row_mask:0xf bank_mask:0xf
  v_dot2c_f32_bf16_dpp v10, v32, v81 row_newbcast:4 row_mask:0xf bank_mask:0xf
  v_dot2c_f32_bf16_dpp v11, v33, v81 row_newbcast:4 row_mask:0xf bank_mask:0xf
  v_dot2c_f32_bf16_dpp v12, v32, v82 row_newbcast:4 row_mask:0xf bank_mask:0xf
  v_dot2c_f32_bf16_dpp v13, v33, v82 row_newbcast:4 row_mask:0xf bank_mask:0xf
  v_dot2c_f32_bf16_dpp v14, v32, v83 row_newbcast:4 row_mask:0xf bank_mask:0xf
  v_dot2c_f32_bf16_dpp v15, v33, v83 row_newbcast:4 row_mask:0xf bank_mask:0xf
  s_waitcnt vmcnt(4)
  buffer_load_dwordx4 v[108:111], v1, s[44:47], s58 offen offset:3072 nt
  v_dot2c_f32_bf16_dpp v8, v32, v84 row_newbcast:5 row_mask:0xf bank_mask:0xf
  v_dot2c_f32_bf16_dpp v9, v33, v84 row_newbcast:5 row_mask:0xf bank_mask:0xf
  v_dot2c_f32_bf16_dpp v10, v32, v85 row_newbcast:5 row_mask:0xf bank_mask:0xf
  v_dot2c_f32_bf16_dpp v11, v33, v85 row_newbcast:5 row_mask:0xf bank_mask:0xf
  v_dot2c_f32_bf16_dpp v12, v32, v86 row_newbcast:5 row_mask:0xf bank_mask:0xf
  v_dot2c_f32_bf16_dpp v13, v33, v86 row_newbcast:5 row_mask:0xf bank_mask:0xf
  v_dot2c_f32_bf16_dpp v14, v32, v87 row_newbcast:5 row_mask:0xf bank_mask:0xf
  v_dot2c_f32_bf16_dpp v15, v33, v87 row_newbcast:5 row_mask:0xf bank_mask:0xf
  s_waitcnt vmcnt(4)
  buffer_load_dwordx4 v[112:115], v1, s[44:47], s59 offen offset:0 nt
  v_dot2c_f32_bf16_dpp v8, v32, v88 row_newbcast:6 row_mask:0xf bank_mask:0xf
  v_dot2c_f32_bf16_dpp v9, v33, v88 row_newbcast:6 row_mask:0xf bank_mask:0xf
  v_dot2c_f32_bf16_dpp v10, v32, v89 row_newbcast:6 row_mask:0xf bank_mask:0xf
  v_dot2c_f32_bf16_dpp v11, v33, v89 row_newbcast:6 row_mask:0xf bank_mask:0xf
  v_dot2c_f32_bf16_dpp v12, v32, v90 row_newbcast:6 row_mask:0xf bank_mask:0xf
  v_dot2c_f32_bf16_dpp v13, v33, v90 row_newbcast:6 row_mask:0xf bank_mask:0xf
  v_dot2c_f32_bf16_dpp v14, v32, v91 row_newbcast:6 row_mask:0xf bank_mask:0xf
  v_dot2c_f32_bf16_dpp v15, v33, v91 row_newbcast:6 row_mask:0xf bank_mask:0xf
  s_waitcnt vmcnt(4)
  buffer_load_dwordx4 v[116:119], v1, s[44:47], s59 offen offset:1024 nt
  v_dot2c_f32_bf16_dpp v8, v32, v92 row_newbcast:7 row_mask:0xf bank_mask:0xf
  v_dot2c_f32_bf16_dpp v9, v33, v92 row_newbcast:7 row_mask:0xf bank_mask:0xf
  v_dot2c_f32_bf16_dpp v10, v32, v93 row_newbcast:7 row_mask:0xf bank_mask:0xf
  v_dot2c_f32_bf16_dpp v11, v33, v93 row_newbcast:7 row_mask:0xf bank_mask:0xf
  v_dot2c_f32_bf16_dpp v12, v32, v94 row_newbcast:7 row_mask:0xf bank_mask:0xf
  v_dot2c_f32_bf16_dpp v13, v33, v94 row_newbcast:7 row_mask:0xf bank_mask:0xf
  v_dot2c_f32_bf16_dpp v14, v32, v95 row_newbcast:7 row_mask:0xf bank_mask:0xf
  v_dot2c_f32_bf16_dpp v15, v33, v95 row_newbcast:7 row_mask:0xf bank_mask:0xf
  s_waitcnt vmcnt(4)
  buffer_load_dwordx4 v[120:123], v1, s[44:47], s59 offen offset:2048 nt
  v_dot2c_f32_bf16_dpp v8, v32, v96 row_newbcast:8 row_mask:0xf bank_mask:0xf
  v_dot2c_f32_bf16_dpp v9, v33, v96 row_newbcast:8 row_mask:0xf bank_mask:0xf
  v_dot2c_f32_bf16_dpp v10, v32, v97 row_newbcast:8 row_mask:0xf bank_mask:0xf
  v_dot2c_f32_bf16_dpp v11, v33, v97 row_newbcast:8 row_mask:0xf bank_mask:0xf
  v_dot2c_f32_bf16_dpp v12, v32, v98 row_newbcast:8 row_mask:0xf bank_mask:0xf
  v_dot2c_f32_bf16_dpp v13, v33, v98 row_newbcast:8 row_mask:0xf bank_mask:0xf
  v_dot2c_f32_bf16_dpp v14, v32, v99 row_newbcast:8 row_mask:0xf bank_mask:0xf
  v_dot2c_f32_bf16_dpp v15, v33, v99 row_newbcast:8 row_mask:0xf bank_mask:0xf
  s_waitcnt vmcnt(4)
  buffer_load_dwordx4 v[124:127], v1, s[44:47], s59 offen offset:3072 nt
  v_dot2c_f32_bf16_dpp v8, v32, v100 row_newbcast:9 row_mask:0xf bank_mask:0xf
  v_dot2c_f32_bf16_dpp v9, v33, v100 row_newbcast:9 row_mask:0xf bank_mask:0xf
  v_dot2c_f32_bf16_dpp v10, v32, v101 row_newbcast:9 row_mask:0xf bank_mask:0xf
  v_dot2c_f32_bf16_dpp v11, v33, v101 row_newbcast:9 row_mask:0xf bank_mask:0xf
  v_dot2c_f32_bf16_dpp v12, v32, v102 row_newbcast:9 row_mask:0xf bank_mask:0xf
  v_dot2c_f32_bf16_dpp v13, v33, v102 row_newbcast:9 row_mask:0xf bank_mask:0xf
  v_dot2c_f32_bf16_dpp v14, v32, v103 row_newbcast:9 row_mask:0xf bank_mask:0xf
  v_dot2c_f32_bf16_dpp v15, v33, v103 row_newbcast:9 row_mask:0xf bank_mask:0xf
  s_waitcnt vmcnt(4)
  buffer_load_dwordx4 v[128:131], v1, s[44:47], s60 offen offset:0 nt
  v_dot2c_f32_bf16_dpp v8, v32, v104 row_newbcast:10 row_mask:0xf bank_mask:0xf
  v_dot2c_f32_bf16_dpp v9, v33, v104 row_newbcast:10 row_mask:0xf bank_mask:0xf
  v_dot2c_f32_bf16_dpp v10, v32, v105 row_newbcast:10 row_mask:0xf bank_mask:0xf
  v_dot2c_f32_bf16_dpp v11, v33, v105 row_newbcast:10 row_mask:0xf bank_mask:0xf
  v_dot2c_f32_bf16_dpp v12, v32, v106 row_newbcast:10 row_mask:0xf bank_mask:0xf
  v_dot2c_f32_bf16_dpp v13, v33, v106 row_newbcast:10 row_mask:0xf bank_mask:0xf
  v_dot2c_f32_bf16_dpp v14, v32, v107 row_newbcast:10 row_mask:0xf bank_mask:0xf
  v_dot2c_f32_bf16_dpp v15, v33, v107 row_newbcast:10 row_mask:0xf bank_mask:0xf
  s_waitcnt vmcnt(4)
  buffer_load_dwordx4 v[132:135], v1, s[44:47], s60 offen offset:1024 nt
  v_dot2c_f32_bf16_dpp v8, v32, v108 row_newbcast:11 row_mask:0xf bank_mask:0xf
  v_dot2c_f32_bf16_dpp v9, v33, v108 row_newbcast:11 row_mask:0xf bank_mask:0xf
  v_dot2c_f32_bf16_dpp v10, v32, v109 row_newbcast:11 row_mask:0xf bank_mask:0xf
  v_dot2c_f32_bf16_dpp v11, v33, v109 row_newbcast:11 row_mask:0xf bank_mask:0xf
  v_dot2c_f32_bf16_dpp v12, v32, v110 row_newbcast:11 row_mask:0xf bank_mask:0xf
  v_dot2c_f32_bf16_dpp v13, v33, v110 row_newbcast:11 row_mask:0xf bank_mask:0xf
  v_dot2c_f32_bf16_dpp v14, v32, v111 row_newbcast:11 row_mask:0xf bank_mask:0xf
  v_dot2c_f32_bf16_dpp v15, v33, v111 row_newbcast:11 row_mask:0xf bank_mask:0xf
  s_waitcnt vmcnt(4)
  buffer_load_dwordx4 v[136:139], v1, s[44:47], s60 offen offset:2048 nt
  v_dot2c_f32_bf16_dpp v8, v32, v112 row_newbcast:12 row_mask:0xf bank_mask:0xf
  v_dot2c_f32_bf16_dpp v9, v33, v112 row_newbcast:12 row_mask:0xf bank_mask:0xf
  v_dot2c_f32_bf16_dpp v10, v32, v113 row_newbcast:12 row_mask:0xf bank_mask:0xf
  v_dot2c_f32_bf16_dpp v11, v33, v113 row_newbcast:12 row_mask:0xf bank_mask:0xf
  v_dot2c_f32_bf16_dpp v12, v32, v114 row_newbcast:12 row_mask:0xf bank_mask:0xf
  v_dot2c_f32_bf16_dpp v13, v33, v114 row_newbcast:12 row_mask:0xf bank_mask:0xf
  v_dot2c_f32_bf16_dpp v14, v32, v115 row_newbcast:12 row_mask:0xf bank_mask:0xf
  v_dot2c_f32_bf16_dpp v15, v33, v115 row_newbcast:12 row_mask:0xf bank_mask:0xf
  s_waitcnt vmcnt(4)
  buffer_load_dwordx4 v[140:143], v1, s[44:47], s60 offen offset:3072 nt
  v_dot2c_f32_bf16_dpp v8, v32, v116 row_newbcast:13 row_mask:0xf bank_mask:0xf
  v_dot2c_f32_bf16_dpp v9, v33, v116 row_newbcast:13 row_mask:0xf bank_mask:0xf
  v_dot2c_f32_bf16_dpp v10, v32, v117 row_newbcast:13 row_mask:0xf bank_mask:0xf
  v_dot2c_f32_bf16_dpp v11, v33, v117 row_newbcast:13 row_mask:0xf bank_mask:0xf
  v_dot2c_f32_bf16_dpp v12, v32, v118 row_newbcast:13 row_mask:0xf bank_mask:0xf
  v_dot2c_f32_bf16_dpp v13, v33, v118 row_newbcast:13 row_mask:0xf bank_mask:0xf
  v_dot2c_f32_bf16_dpp v14, v32, v119 row_newbcast:13 row_mask:0xf bank_mask:0xf
  v_dot2c_f32_bf16_dpp v15, v33, v119 row_newbcast:13 row_mask:0xf bank_mask:0xf
  s_waitcnt vmcnt(4)
  buffer_load_dwordx4 v[144:147], v1, s[44:47], s61 offen offset:0 nt
  v_dot2c_f32_bf16_dpp v8, v32, v120 row_newbcast:14 row_mask:0xf bank_mask:0xf
  v_dot2c_f32_bf16_dpp v9, v33, v120 row_newbcast:14 row_mask:0xf bank_mask:0xf
  v_dot2c_f32_bf16_dpp v10, v32, v121 row_newbcast:14 row_mask:0xf bank_mask:0xf
  v_dot2c_f32_bf16_dpp v11, v33, v121 row_newbcast:14 row_mask:0xf bank_mask:0xf
  v_dot2c_f32_bf16_dpp v12, v32, v122 row_newbcast:14 row_mask:0xf bank_mask:0xf
  v_dot2c_f32_bf16_dpp v13, v33, v122 row_newbcast:14 row_mask:0xf bank_mask:0xf
  v_dot2c_f32_bf16_dpp v14, v32, v123 row_newbcast:14 row_mask:0xf bank_mask:0xf
  v_dot2c_f32_bf16_dpp v15, v33, v123 row_newbcast:14 row_mask:0xf bank_mask:0xf
  s_waitcnt vmcnt(4)
  buffer_load_dwordx4 v[148:151], v1, s[44:47], s61 offen offset:1024 nt
  v_dot2c_f32_bf16_dpp v8, v32, v124 row_newbcast:15 row_mask:0xf bank_mask:0xf
  v_dot2c_f32_bf16_dpp v9, v33, v124 row_newbcast:15 row_mask:0xf bank_mask:0xf
  v_dot2c_f32_bf16_dpp v10, v32, v125 row_newbcast:15 row_mask:0xf bank_mask:0xf
  v_dot2c_f32_bf16_dpp v11, v33, v125 row_newbcast:15 row_mask:0xf bank_mask:0xf
  v_dot2c_f32_bf16_dpp v12, v32, v126 row_newbcast:15 row_mask:0xf bank_mask:0xf
  v_dot2c_f32_bf16_dpp v13, v33, v126 row_newbcast:15 row_mask:0xf bank_mask:0xf
  v_dot2c_f32_bf16_dpp v14, v32, v127 row_newbcast:15 row_mask:0xf bank_mask:0xf
  v_dot2c_f32_bf16_dpp v15, v33, v127 row_newbcast:15 row_mask:0xf bank_mask:0xf
  s_waitcnt vmcnt(4)
  buffer_load_dwordx4 v[152:155], v1, s[44:47], s61 offen offset:2048 nt
  v_dot2c_f32_bf16_dpp v8, v34, v128 row_newbcast:0 row_mask:0xf bank_mask:0xf
  v_dot2c_f32_bf16_dpp v9, v35, v128 row_newbcast:0 row_mask:0xf bank_mask:0xf
  v_dot2c_f32_bf16_dpp v10, v34, v129 row_newbcast:0 row_mask:0xf bank_mask:0xf
  v_dot2c_f32_bf16_dpp v11, v35, v129 row_newbcast:0 row_mask:0xf bank_mask:0xf
  v_dot2c_f32_bf16_dpp v12, v34, v130 row_newbcast:0 row_mask:0xf bank_mask:0xf
  v_dot2c_f32_bf16_dpp v13, v35, v130 row_newbcast:0 row_mask:0xf bank_mask:0xf
  v_dot2c_f32_bf16_dpp v14, v34, v131 row_newbcast:0 row_mask:0xf bank_mask:0xf
  v_dot2c_f32_bf16_dpp v15, v35, v131 row_newbcast:0 row_mask:0xf bank_mask:0xf
  s_waitcnt vmcnt(4)
  buffer_load_dwordx4 v[156:159], v1, s[44:47], s61 offen offset:3072 nt
  v_dot2c_f32_bf16_dpp v8, v34, v132 row_newbcast:1 row_mask:0xf bank_mask:0xf
  v_dot2c_f32_bf16_dpp v9, v35, v132 row_newbcast:1 row_mask:0xf bank_mask:0xf
  v_dot2c_f32_bf16_dpp v10, v34, v133 row_newbcast:1 row_mask:0xf bank_mask:0xf
  v_dot2c_f32_bf16_dpp v11, v35, v133 row_newbcast:1 row_mask:0xf bank_mask:0xf
  v_dot2c_f32_bf16_dpp v12, v34, v134 row_newbcast:1 row_mask:0xf bank_mask:0xf
  v_dot2c_f32_bf16_dpp v13, v35, v134 row_newbcast:1 row_mask:0xf bank_mask:0xf
  v_dot2c_f32_bf16_dpp v14, v34, v135 row_newbcast:1 row_mask:0xf bank_mask:0xf
  v_dot2c_f32_bf16_dpp v15, v35, v135 row_newbcast:1 row_mask:0xf bank_mask:0xf
  s_waitcnt vmcnt(4)
  buffer_load_dwordx4 v[160:163], v1, s[44:47], s62 offen offset:0 nt
  v_dot2c_f32_bf16_dpp v8, v34, v136 row_newbcast:2 row_mask:0xf bank_mask:0xf
  v_dot2c_f32_bf16_dpp v9, v35, v136 row_newbcast:2 row_mask:0xf bank_mask:0xf
  v_dot2c_f32_bf16_dpp v10, v34, v137 row_newbcast:2 row_mask:0xf bank_mask:0xf
  v_dot2c_f32_bf16_dpp v11, v35, v137 row_newbcast:2 row_mask:0xf bank_mask:0xf
  v_dot2c_f32_bf16_dpp v12, v34, v138 row_newbcast:2 row_mask:0xf bank_mask:0xf
  v_dot2c_f32_bf16_dpp v13, v35, v138 row_newbcast:2 row_mask:0xf bank_mask:0xf
  v_dot2c_f32_bf16_dpp v14, v34, v139 row_newbcast:2 row_mask:0xf bank_mask:0xf
  v_dot2c_f32_bf16_dpp v15, v35, v139 row_newbcast:2 row_mask:0xf bank_mask:0xf
  s_waitcnt vmcnt(4)
  buffer_load_dwordx4 v[164:167], v1, s[44:47], s62 offen offset:1024 nt
  v_dot2c_f32_bf16_dpp v8, v34, v140 row_newbcast:3 row_mask:0xf bank_mask:0xf
  v_dot2c_f32_bf16_dpp v9, v35, v140 row_newbcast:3 row_mask:0xf bank_mask:0xf
  v_dot2c_f32_bf16_dpp v10, v34, v141 row_newbcast:3 row_mask:0xf bank_mask:0xf
  v_dot2c_f32_bf16_dpp v11, v35, v141 row_newbcast:3 row_mask:0xf bank_mask:0xf
  v_dot2c_f32_bf16_dpp v12, v34, v142 row_newbcast:3 row_mask:0xf bank_mask:0xf
  v_dot2c_f32_bf16_dpp v13, v35, v142 row_newbcast:3 row_mask:0xf bank_mask:0xf
  v_dot2c_f32_bf16_dpp v14, v34, v143 row_newbcast:3 row_mask:0xf bank_mask:0xf
  v_dot2c_f32_bf16_dpp v15, v35, v143 row_newbcast:3 row_mask:0xf bank_mask:0xf
  s_waitcnt vmcnt(4)
  buffer_load_dwordx4 v[168:171], v1, s[44:47], s62 offen offset:2048 nt
  v_dot2c_f32_bf16_dpp v8, v34, v144 row_newbcast:4 row_mask:0xf bank_mask:0xf
  v_dot2c_f32_bf16_dpp v9, v35, v144 row_newbcast:4 row_mask:0xf bank_mask:0xf
  v_dot2c_f32_bf16_dpp v10, v34, v145 row_newbcast:4 row_mask:0xf bank_mask:0xf
  v_dot2c_f32_bf16_dpp v11, v35, v145 row_newbcast:4 row_mask:0xf bank_mask:0xf
  v_dot2c_f32_bf16_dpp v12, v34, v146 row_newbcast:4 row_mask:0xf bank_mask:0xf
  v_dot2c_f32_bf16_dpp v13, v35, v146 row_newbcast:4 row_mask:0xf bank_mask:0xf
  v_dot2c_f32_bf16_dpp v14, v34, v147 row_newbcast:4 row_mask:0xf bank_mask:0xf
  v_dot2c_f32_bf16_dpp v15, v35, v147 row_newbcast:4 row_mask:0xf bank_mask:0xf
  s_waitcnt vmcnt(4)
  buffer_load_dwordx4 v[172:175], v1, s[44:47], s62 offen offset:3072 nt
  v_dot2c_f32_bf16_dpp v8, v34, v148 row_newbcast:5 row_mask:0xf bank_mask:0xf
  v_dot2c_f32_bf16_dpp v9, v35, v148 row_newbcast:5 row_mask:0xf bank_mask:0xf
  v_dot2c_f32_bf16_dpp v10, v34, v149 row_newbcast:5 row_mask:0xf bank_mask:0xf
  v_dot2c_f32_bf16_dpp v11, v35, v149 row_newbcast:5 row_mask:0xf bank_mask:0xf
  v_dot2c_f32_bf16_dpp v12, v34, v150 row_newbcast:5 row_mask:0xf bank_mask:0xf
  v_dot2c_f32_bf16_dpp v13, v35, v150 row_newbcast:5 row_mask:0xf bank_mask:0xf
  v_dot2c_f32_bf16_dpp v14, v34, v151 row_newbcast:5 row_mask:0xf bank_mask:0xf
  v_dot2c_f32_bf16_dpp v15, v35, v151 row_newbcast:5 row_mask:0xf bank_mask:0xf
  s_waitcnt vmcnt(4)
  buffer_load_dwordx4 v[176:179], v1, s[44:47], s63 offen offset:0 nt
  v_dot2c_f32_bf16_dpp v8, v34, v152 row_newbcast:6 row_mask:0xf bank_mask:0xf
  v_dot2c_f32_bf16_dpp v9, v35, v152 row_newbcast:6 row_mask:0xf bank_mask:0xf
  v_dot2c_f32_bf16_dpp v10, v34, v153 row_newbcast:6 row_mask:0xf bank_mask:0xf
  v_dot2c_f32_bf16_dpp v11, v35, v153 row_newbcast:6 row_mask:0xf bank_mask:0xf
  v_dot2c_f32_bf16_dpp v12, v34, v154 row_newbcast:6 row_mask:0xf bank_mask:0xf
  v_dot2c_f32_bf16_dpp v13, v35, v154 row_newbcast:6 row_mask:0xf bank_mask:0xf
  v_dot2c_f32_bf16_dpp v14, v34, v155 row_newbcast:6 row_mask:0xf bank_mask:0xf
  v_dot2c_f32_bf16_dpp v15, v35, v155 row_newbcast:6 row_mask:0xf bank_mask:0xf
  s_waitcnt vmcnt(4)
  buffer_load_dwordx4 v[180:183], v1, s[44:47], s63 offen offset:1024 nt
  v_dot2c_f32_bf16_dpp v8, v34, v156 row_newbcast:7 row_mask:0xf bank_mask:0xf
  v_dot2c_f32_bf16_dpp v9, v35, v156 row_newbcast:7 row_mask:0xf bank_mask:0xf
  v_dot2c_f32_bf16_dpp v10, v34, v157 row_newbcast:7 row_mask:0xf bank_mask:0xf
  v_dot2c_f32_bf16_dpp v11, v35, v157 row_newbcast:7 row_mask:0xf bank_mask:0xf
  v_dot2c_f32_bf16_dpp v12, v34, v158 row_newbcast:7 row_mask:0xf bank_mask:0xf
  v_dot2c_f32_bf16_dpp v13, v35, v158 row_newbcast:7 row_mask:0xf bank_mask:0xf
  v_dot2c_f32_bf16_dpp v14, v34, v159 row_newbcast:7 row_mask:0xf bank_mask:0xf
  v_dot2c_f32_bf16_dpp v15, v35, v159 row_newbcast:7 row_mask:0xf bank_mask:0xf
  s_waitcnt vmcnt(4)
  buffer_load_dwordx4 v[184:187], v1, s[44:47], s63 offen offset:2048 nt
  v_dot2c_f32_bf16_dpp v8, v34, v160 row_newbcast:8 row_mask:0xf bank_mask:0xf
  v_dot2c_f32_bf16_dpp v9, v35, v160 row_newbcast:8 row_mask:0xf bank_mask:0xf
  v_dot2c_f32_bf16_dpp v10, v34, v161 row_newbcast:8 row_mask:0xf bank_mask:0xf
  v_dot2c_f32_bf16_dpp v11, v35, v161 row_newbcast:8 row_mask:0xf bank_mask:0xf
  v_dot2c_f32_bf16_dpp v12, v34, v162 row_newbcast:8 row_mask:0xf bank_mask:0xf
  v_dot2c_f32_bf16_dpp v13, v35, v162 row_newbcast:8 row_mask:0xf bank_mask:0xf
  v_dot2c_f32_bf16_dpp v14, v34, v163 row_newbcast:8 row_mask:0xf bank_mask:0xf
  v_dot2c_f32_bf16_dpp v15, v35, v163 row_newbcast:8 row_mask:0xf bank_mask:0xf
  s_waitcnt vmcnt(4)
  buffer_load_dwordx4 v[188:191], v1, s[44:47], s63 offen offset:3072 nt
  v_dot2c_f32_bf16_dpp v8, v34, v164 row_newbcast:9 row_mask:0xf bank_mask:0xf
  v_dot2c_f32_bf16_dpp v9, v35, v164 row_newbcast:9 row_mask:0xf bank_mask:0xf
  v_dot2c_f32_bf16_dpp v10, v34, v165 row_newbcast:9 row_mask:0xf bank_mask:0xf
  v_dot2c_f32_bf16_dpp v11, v35, v165 row_newbcast:9 row_mask:0xf bank_mask:0xf
  v_dot2c_f32_bf16_dpp v12, v34, v166 row_newbcast:9 row_mask:0xf bank_mask:0xf
  v_dot2c_f32_bf16_dpp v13, v35, v166 row_newbcast:9 row_mask:0xf bank_mask:0xf
  v_dot2c_f32_bf16_dpp v14, v34, v167 row_newbcast:9 row_mask:0xf bank_mask:0xf
  v_dot2c_f32_bf16_dpp v15, v35, v167 row_newbcast:9 row_mask:0xf bank_mask:0xf
  s_waitcnt vmcnt(4)
  buffer_load_dwordx4 v[64:67], v1, s[48:51], s56 offen offset:0 nt
  v_dot2c_f32_bf16_dpp v8, v34, v168 row_newbcast:10 row_mask:0xf bank_mask:0xf
  v_dot2c_f32_bf16_dpp v9, v35, v168 row_newbcast:10 row_mask:0xf bank_mask:0xf
  v_dot2c_f32_bf16_dpp v10, v34, v169 row_newbcast:10 row_mask:0xf bank_mask:0xf
  v_dot2c_f32_bf16_dpp v11, v35, v169 row_newbcast:10 row_mask:0xf bank_mask:0xf
  v_dot2c_f32_bf16_dpp v12, v34, v170 row_newbcast:10 row_mask:0xf bank_mask:0xf
  v_dot2c_f32_bf16_dpp v13, v35, v170 row_newbcast:10 row_mask:0xf bank_mask:0xf
  v_dot2c_f32_bf16_dpp v14, v34, v171 row_newbcast:10 row_mask:0xf bank_mask:0xf
  v_dot2c_f32_bf16_dpp v15, v35, v171 row_newbcast:10 row_mask:0xf bank_mask:0xf
  s_waitcnt vmcnt(4)
  buffer_load_dwordx4 v[68:71], v1, s[48:51], s56 offen offset:1024 nt
  v_dot2c_f32_bf16_dpp v8, v34, v172 row_newbcast:11 row_mask:0xf bank_mask:0xf
  v_dot2c_f32_bf16_dpp v9, v35, v172 row_newbcast:11 row_mask:0xf bank_mask:0xf
  v_dot2c_f32_bf16_dpp v10, v34, v173 row_newbcast:11 row_mask:0xf bank_mask:0xf
  v_dot2c_f32_bf16_dpp v11, v35, v173 row_newbcast:11 row_mask:0xf bank_mask:0xf
  v_dot2c_f32_bf16_dpp v12, v34, v174 row_newbcast:11 row_mask:0xf bank_mask:0xf
  v_dot2c_f32_bf16_dpp v13, v35, v174 row_newbcast:11 row_mask:0xf bank_mask:0xf
  v_dot2c_f32_bf16_dpp v14, v34, v175 row_newbcast:11 row_mask:0xf bank_mask:0xf
  v_dot2c_f32_bf16_dpp v15, v35, v175 row_newbcast:11 row_mask:0xf bank_mask:0xf
  s_waitcnt vmcnt(4)
  buffer_load_dwordx4 v[72:75], v1, s[48:51], s56 offen offset:2048 nt
  v_dot2c_f32_bf16_dpp v8, v34, v176 row_newbcast:12 row_mask:0xf bank_mask:0xf
  v_dot2c_f32_bf16_dpp v9, v35, v176 row_newbcast:12 row_mask:0xf bank_mask:0xf
  v_dot2c_f32_bf16_dpp v10, v34, v177 row_newbcast:12 row_mask:0xf bank_mask:0xf
  v_dot2c_f32_bf16_dpp v11, v35, v177 row_newbcast:12 row_mask:0xf bank_mask:0xf
  v_dot2c_f32_bf16_dpp v12, v34, v178 row_newbcast:12 row_mask:0xf bank_mask:0xf
  v_dot2c_f32_bf16_dpp v13, v35, v178 row_newbcast:12 row_mask:0xf bank_mask:0xf
  v_dot2c_f32_bf16_dpp v14, v34, v179 row_newbcast:12 row_mask:0xf bank_mask:0xf
  v_dot2c_f32_bf16_dpp v15, v35, v179 row_newbcast:12 row_mask:0xf bank_mask:0xf
  s_waitcnt vmcnt(4)
  buffer_load_dwordx4 v[76:79], v1, s[48:51], s56 offen offset:3072 nt
  v_dot2c_f32_bf16_dpp v8, v34, v180 row_newbcast:13 row_mask:0xf bank_mask:0xf
  v_dot2c_f32_bf16_dpp v9, v35, v180 row_newbcast:13 row_mask:0xf bank_mask:0xf
  v_dot2c_f32_bf16_dpp v10, v34, v181 row_newbcast:13 row_mask:0xf bank_mask:0xf
  v_dot2c_f32_bf16_dpp v11, v35, v181 row_newbcast:13 row_mask:0xf bank_mask:0xf
  v_dot2c_f32_bf16_dpp v12, v34, v182 row_newbcast:13 row_mask:0xf bank_mask:0xf
  v_dot2c_f32_bf16_dpp v13, v35, v182 row_newbcast:13 row_mask:0xf bank_mask:0xf
  v_dot2c_f32_bf16_dpp v14, v34, v183 row_newbcast:13 row_mask:0xf bank_mask:0xf
  v_dot2c_f32_bf16_dpp v15, v35, v183 row_newbcast:13 row_mask:0xf bank_mask:0xf
  s_waitcnt vmcnt(4)
  buffer_load_dwordx4 v[80:83], v1, s[48:51], s57 offen offset:0 nt
  v_dot2c_f32_bf16_dpp v8, v34, v184 row_newbcast:14 row_mask:0xf bank_mask:0xf
  v_dot2c_f32_bf16_dpp v9, v35, v184 row_newbcast:14 row_mask:0xf bank_mask:0xf
  v_dot2c_f32_bf16_dpp v10, v34, v185 row_newbcast:14 row_mask:0xf bank_mask:0xf
  v_dot2c_f32_bf16_dpp v11, v35, v185 row_newbcast:14 row_mask:0xf bank_mask:0xf
  v_dot2c_f32_bf16_dpp v12, v34, v186 row_newbcast:14 row_mask:0xf bank_mask:0xf
  v_dot2c_f32_bf16_dpp v13, v35, v186 row_newbcast:14 row_mask:0xf bank_mask:0xf
  v_dot2c_f32_bf16_dpp v14, v34, v187 row_newbcast:14 row_mask:0xf bank_mask:0xf
  v_dot2c_f32_bf16_dpp v15, v35, v187 row_newbcast:14 row_mask:0xf bank_mask:0xf
  s_waitcnt vmcnt(4)
  buffer_load_dwordx4 v[84:87], v1, s[48:51], s57 offen offset:1024 nt
  v_dot2c_f32_bf16_dpp v8, v34, v188 row_newbcast:15 row_mask:0xf bank_mask:0xf
  v_dot2c_f32_bf16_dpp v9, v35, v188 row_newbcast:15 row_mask:0xf bank_mask:0xf
  v_dot2c_f32_bf16_dpp v10, v34, v189 row_newbcast:15 row_mask:0xf bank_mask:0xf
  v_dot2c_f32_bf16_dpp v11, v35, v189 row_newbcast:15 row_mask:0xf bank_mask:0xf
  v_dot2c_f32_bf16_dpp v12, v34, v190 row_newbcast:15 row_mask:0xf bank_mask:0xf
  v_dot2c_f32_bf16_dpp v13, v35, v190 row_newbcast:15 row_mask:0xf bank_mask:0xf
  v_dot2c_f32_bf16_dpp v14, v34, v191 row_newbcast:15 row_mask:0xf bank_mask:0xf
  v_dot2c_f32_bf16_dpp v15, v35, v191 row_newbcast:15 row_mask:0xf bank_mask:0xf
  s_mov_b32 s44, s48
  s_mov_b32 s45, s49
  s_add_u32 s48, s48, 131072
  s_addc_u32 s49, s49, 0
  s_add_u32 s34, s34, 1
  s_cmp_lt_u32 s34, 15
  s_cbranch_scc1 L_vloop
  s_waitcnt vmcnt(4)
  buffer_load_dwordx4 v[88:91], v1, s[44:47], s57 offen offset:2048 nt
  ds_read_b32 v32, v2 offset:512
  ds_read_b32 v34, v2 offset:768
  s_waitcnt lgkmcnt(0)
  v_lshlrev_b32 v33, 16, v32
  v_lshlrev_b32 v35, 16, v34
  v_dot2c_f32_bf16_dpp v8, v32, v64 row_newbcast:0 row_mask:0xf bank_mask:0xf
  v_dot2c_f32_bf16_dpp v9, v33, v64 row_newbcast:0 row_mask:0xf bank_mask:0xf
  v_dot2c_f32_bf16_dpp v10, v32, v65 row_newbcast:0 row_mask:0xf bank_mask:0xf
  v_dot2c_f32_bf16_dpp v11, v33, v65 row_newbcast:0 row_mask:0xf bank_mask:0xf
  v_dot2c_f32_bf16_dpp v12, v32, v66 row_newbcast:0 row_mask:0xf bank_mask:0xf
  v_dot2c_f32_bf16_dpp v13, v33, v66 row_newbcast:0 row_mask:0xf bank_mask:0xf
  v_dot2c_f32_bf16_dpp v14, v32, v67 row_newbcast:0 row_mask:0xf bank_mask:0xf
  v_dot2c_f32_bf16_dpp v15, v33, v67 row_newbcast:0 row_mask:0xf bank_mask:0xf
  s_waitcnt vmcnt(4)
  buffer_load_dwordx4 v[92:95], v1, s[44:47], s57 offen offset:3072 nt
  v_dot2c_f32_bf16_dpp v8, v32, v68 row_newbcast:1 row_mask:0xf bank_mask:0xf
  v_dot2c_f32_bf16_dpp v9, v33, v68 row_newbcast:1 row_mask:0xf bank_mask:0xf
  v_dot2c_f32_bf16_dpp v10, v32, v69 row_newbcast:1 row_mask:0xf bank_mask:0xf
  v_dot2c_f32_bf16_dpp v11, v33, v69 row_newbcast:1 row_mask:0xf bank_mask:0xf
  v_dot2c_f32_bf16_dpp v12, v32, v70 row_newbcast:1 row_mask:0xf bank_mask:0xf
  v_dot2c_f32_bf16_dpp v13, v33, v70 row_newbcast:1 row_mask:0xf bank_mask:0xf
  v_dot2c_f32_bf16_dpp v14, v32, v71 row_newbcast:1 row_mask:0xf bank_mask:0xf
  v_dot2c_f32_bf16_dpp v15, v33, v71 row_newbcast:1 row_mask:0xf bank_mask:0xf
  s_waitcnt vmcnt(4)
  buffer_load_dwordx4 v[96:99], v1, s[44:47], s58 offen offset:0 nt
  v_dot2c_f32_bf16_dpp v8, v32, v72 row_newbcast:2 row_mask:0xf bank_mask:0xf
  v_dot2c_f32_bf16_dpp v9, v33, v72 row_newbcast:2 row_mask:0xf bank_mask:0xf
  v_dot2c_f32_bf16_dpp v10, v32, v73 row_newbcast:2 row_mask:0xf bank_mask:0xf
  v_dot2c_f32_bf16_dpp v11, v33, v73 row_newbcast:2 row_mask:0xf bank_mask:0xf
  v_dot2c_f32_bf16_dpp v12, v32, v74 row_newbcast:2 row_mask:0xf bank_mask:0xf
  v_dot2c_f32_bf16_dpp v13, v33, v74 row_newbcast:2 row_mask:0xf bank_mask:0xf
  v_dot2c_f32_bf16_dpp v14, v32, v75 row_newbcast:2 row_mask:0xf bank_mask:0xf
  v_dot2c_f32_bf16_dpp v15, v33, v75 row_newbcast:2 row_mask:0xf bank_mask:0xf
  s_waitcnt vmcnt(4)
  buffer_load_dwordx4 v[100:103], v1, s[44:47], s58 offen offset:1024 nt
  v_dot2c_f32_bf16_dpp v8, v32, v76 row_newbcast:3 row_mask:0xf bank_mask:0xf
  v_dot2c_f32_bf16_dpp v9, v33, v76 row_newbcast:3 row_mask:0xf bank_mask:0xf
  v_dot2c_f32_bf16_dpp v10, v32, v77 row_newbcast:3 row_mask:0xf bank_mask:0xf
  v_dot2c_f32_bf16_dpp v11, v33, v77 row_newbcast:3 row_mask:0xf bank_mask:0xf
  v_dot2c_f32_bf16_dpp v12, v32, v78 row_newbcast:3 row_mask:0xf bank_mask:0xf
  v_dot2c_f32_bf16_dpp v13, v33, v78 row_newbcast:3 row_mask:0xf bank_mask:0xf
  v_dot2c_f32_bf16_dpp v14, v32, v79 row_newbcast:3 row_mask:0xf bank_mask:0xf
  v_dot2c_f32_bf16_dpp v15, v33, v79 row_newbcast:3 row_mask:0xf bank_mask:0xf
  s_waitcnt vmcnt(4)
  buffer_load_dwordx4 v[104:107], v1, s[44:47], s58 offen offset:2048 nt
  v_dot2c_f32_bf16_dpp v8, v32, v80 row_newbcast:4 row_mask:0xf bank_mask:0xf
  v_dot2c_f32_bf16_dpp v9, v33, v80 row_newbcast:4 row_mask:0xf bank_mask:0xf
  v_dot2c_f32_bf16_dpp v10, v32, v81 row_newbcast:4 row_mask:0xf bank_mask:0xf
  v_dot2c_f32_bf16_dpp v11, v33, v81 row_newbcast:4 row_mask:0xf bank_mask:0xf
  v_dot2c_f32_bf16_dpp v12, v32, v82 row_newbcast:4 row_mask:0xf bank_mask:0xf
  v_dot2c_f32_bf16_dpp v13, v33, v82 row_newbcast:4 row_mask:0xf bank_mask:0xf
  v_dot2c_f32_bf16_dpp v14, v32, v83 row_newbcast:4 row_mask:0xf bank_mask:0xf
  v_dot2c_f32_bf16_dpp v15, v33, v83 row_newbcast:4 row_mask:0xf bank_mask:0xf
  s_waitcnt vmcnt(4)
  buffer_load_dwordx4 v[108:111], v1, s[44:47], s58 offen offset:3072 nt
  v_dot2c_f32_bf16_dpp v8, v32, v84 row_newbcast:5 row_mask:0xf bank_mask:0xf
  v_dot2c_f32_bf16_dpp v9, v33, v84 row_newbcast:5 row_mask:0xf bank_mask:0xf
  v_dot2c_f32_bf16_dpp v10, v32, v85 row_newbcast:5 row_mask:0xf bank_mask:0xf
  v_dot2c_f32_bf16_dpp v11, v33, v85 row_newbcast:5 row_mask:0xf bank_mask:0xf
  v_dot2c_f32_bf16_dpp v12, v32, v86 row_newbcast:5 row_mask:0xf bank_mask:0xf
  v_dot2c_f32_bf16_dpp v13, v33, v86 row_newbcast:5 row_mask:0xf bank_mask:0xf
  v_dot2c_f32_bf16_dpp v14, v32, v87 row_newbcast:5 row_mask:0xf bank_mask:0xf
  v_dot2c_f32_bf16_dpp v15, v33, v87 row_newbcast:5 row_mask:0xf bank_mask:0xf
  s_waitcnt vmcnt(4)
  buffer_load_dwordx4 v[112:115], v1, s[44:47], s59 offen offset:0 nt
  v_dot2c_f32_bf16_dpp v8, v32, v88 row_newbcast:6 row_mask:0xf bank_mask:0xf
  v_dot2c_f32_bf16_dpp v9, v33, v88 row_newbcast:6 row_mask:0xf bank_mask:0xf
  v_dot2c_f32_bf16_dpp v10, v32, v89 row_newbcast:6 row_mask:0xf bank_mask:0xf
  v_dot2c_f32_bf16_dpp v11, v33, v89 row_newbcast:6 row_mask:0xf bank_mask:0xf
  v_dot2c_f32_bf16_dpp v12, v32, v90 row_newbcast:6 row_mask:0xf bank_mask:0xf
  v_dot2c_f32_bf16_dpp v13, v33, v90 row_newbcast:6 row_mask:0xf bank_mask:0xf
  v_dot2c_f32_bf16_dpp v14, v32, v91 row_newbcast:6 row_mask:0xf bank_mask:0xf
  v_dot2c_f32_bf16_dpp v15, v33, v91 row_newbcast:6 row_mask:0xf bank_mask:0xf
  s_waitcnt vmcnt(4)
  buffer_load_dwordx4 v[116:119], v1, s[44:47], s59 offen offset:1024 nt
  v_dot2c_f32_bf16_dpp v8, v32, v92 row_newbcast:7 row_mask:0xf bank_mask:0xf
  v_dot2c_f32_bf16_dpp v9, v33, v92 row_newbcast:7 row_mask:0xf bank_mask:0xf
  v_dot2c_f32_bf16_dpp v10, v32, v93 row_newbcast:7 row_mask:0xf bank_mask:0xf
  v_dot2c_f32_bf16_dpp v11, v33, v93 row_newbcast:7 row_mask:0xf bank_mask:0xf
  v_dot2c_f32_bf16_dpp v12, v32, v94 row_newbcast:7 row_mask:0xf bank_mask:0xf
  v_dot2c_f32_bf16_dpp v13, v33, v94 row_newbcast:7 row_mask:0xf bank_mask:0xf
  v_dot2c_f32_bf16_dpp v14, v32, v95 row_newbcast:7 row_mask:0xf bank_mask:0xf
  v_dot2c_f32_bf16_dpp v15, v33, v95 row_newbcast:7 row_mask:0xf bank_mask:0xf
  buffer_load_dwordx4 v[120:123], v1, s[44:47], s59 offen offset:2048 nt
  buffer_load_dwordx4 v[124:127], v1, s[44:47], s59 offen offset:3072 nt
  s_waitcnt vmcnt(7)
  v_dot2c_f32_bf16_dpp v8, v32, v96 row_newbcast:8 row_mask:0xf bank_mask:0xf
  v_dot2c_f32_bf16_dpp v9, v33, v96 row_newbcast:8 row_mask:0xf bank_mask:0xf
  v_dot2c_f32_bf16_dpp v10, v32, v97 row_newbcast:8 row_mask:0xf bank_mask:0xf
  v_dot2c_f32_bf16_dpp v11, v33, v97 row_newbcast:8 row_mask:0xf bank_mask:0xf
  v_dot2c_f32_bf16_dpp v12, v32, v98 row_newbcast:8 row_mask:0xf bank_mask:0xf
  v_dot2c_f32_bf16_dpp v13, v33, v98 row_newbcast:8 row_mask:0xf bank_mask:0xf
  v_dot2c_f32_bf16_dpp v14, v32, v99 row_newbcast:8 row_mask:0xf bank_mask:0xf
  v_dot2c_f32_bf16_dpp v15, v33, v99 row_newbcast:8 row_mask:0xf bank_mask:0xf
  buffer_load_dwordx4 v[128:131], v1, s[44:47], s60 offen offset:0 nt
  buffer_load_dwordx4 v[132:135], v1, s[44:47], s60 offen offset:1024 nt
  s_waitcnt vmcnt(8)
  v_dot2c_f32_bf16_dpp v8, v32, v100 row_newbcast:9 row_mask:0xf bank_mask:0xf
  v_dot2c_f32_bf16_dpp v9, v33, v100 row_newbcast:9 row_mask:0xf bank_mask:0xf
  v_dot2c_f32_bf16_dpp v10, v32, v101 row_newbcast:9 row_mask:0xf bank_mask:0xf
  v_dot2c_f32_bf16_dpp v11, v33, v101 row_newbcast:9 row_mask:0xf bank_mask:0xf
  v_dot2c_f32_bf16_dpp v12, v32, v102 row_newbcast:9 row_mask:0xf bank_mask:0xf
  v_dot2c_f32_bf16_dpp v13, v33, v102 row_newbcast:9 row_mask:0xf bank_mask:0xf
  v_dot2c_f32_bf16_dpp v14, v32, v103 row_newbcast:9 row_mask:0xf bank_mask:0xf
  v_dot2c_f32_bf16_dpp v15, v33, v103 row_newbcast:9 row_mask:0xf bank_mask:0xf
  buffer_load_dwordx4 v[136:139], v1, s[44:47], s60 offen offset:2048 nt
  buffer_load_dwordx4 v[140:143], v1, s[44:47], s60 offen offset:3072 nt
  s_waitcnt vmcnt(9)
  v_dot2c_f32_bf16_dpp v8, v32, v104 row_newbcast:10 row_mask:0xf bank_mask:0xf
  v_dot2c_f32_bf16_dpp v9, v33, v104 row_newbcast:10 row_mask:0xf bank_mask:0xf
  v_dot2c_f32_bf16_dpp v10, v32, v105 row_newbcast:10 row_mask:0xf bank_mask:0xf
  v_dot2c_f32_bf16_dpp v11, v33, v105 row_newbcast:10 row_mask:0xf bank_mask:0xf
  v_dot2c_f32_bf16_dpp v12, v32, v106 row_newbcast:10 row_mask:0xf bank_mask:0xf
  v_dot2c_f32_bf16_dpp v13, v33, v106 row_newbcast:10 row_mask:0xf bank_mask:0xf
  v_dot2c_f32_bf16_dpp v14, v32, v107 row_newbcast:10 row_mask:0xf bank_mask:0xf
  v_dot2c_f32_bf16_dpp v15, v33, v107 row_newbcast:10 row_mask:0xf bank_mask:0xf
  buffer_load_dwordx4 v[144:147], v1, s[44:47], s61 offen offset:0 nt
  buffer_load_dwordx4 v[148:151], v1, s[44:47], s61 offen offset:1024 nt
  s_waitcnt vmcnt(10)
  v_dot2c_f32_bf16_dpp v8, v32, v108 row_newbcast:11 row_mask:0xf bank_mask:0xf
  v_dot2c_f32_bf16_dpp v9, v33, v108 row_newbcast:11 row_mask:0xf bank_mask:0xf
  v_dot2c_f32_bf16_dpp v10, v32, v109 row_newbcast:11 row_mask:0xf bank_mask:0xf
  v_dot2c_f32_bf16_dpp v11, v33, v109 row_newbcast:11 row_mask:0xf bank_mask:0xf
  v_dot2c_f32_bf16_dpp v12, v32, v110 row_newbcast:11 row_mask:0xf bank_mask:0xf
  v_dot2c_f32_bf16_dpp v13, v33, v110 row_newbcast:11 row_mask:0xf bank_mask:0xf
  v_dot2c_f32_bf16_dpp v14, v32, v111 row_newbcast:11 row_mask:0xf bank_mask:0xf
  v_dot2c_f32_bf16_dpp v15, v33, v111 row_newbcast:11 row_mask:0xf bank_mask:0xf
  buffer_load_dwordx4 v[152:155], v1, s[44:47], s61 offen offset:2048 nt
  buffer_load_dwordx4 v[156:159], v1, s[44:47], s61 offen offset:3072 nt
  s_waitcnt vmcnt(11)
  v_dot2c_f32_bf16_dpp v8, v32, v112 row_newbcast:12 row_mask:0xf bank_mask:0xf
  v_dot2c_f32_bf16_dpp v9, v33, v112 row_newbcast:12 row_mask:0xf bank_mask:0xf
  v_dot2c_f32_bf16_dpp v10, v32, v113 row_newbcast:12 row_mask:0xf bank_mask:0xf
  v_dot2c_f32_bf16_dpp v11, v33, v113 row_newbcast:12 row_mask:0xf bank_mask:0xf
  v_dot2c_f32_bf16_dpp v12, v32, v114 row_newbcast:12 row_mask:0xf bank_mask:0xf
  v_dot2c_f32_bf16_dpp v13, v33, v114 row_newbcast:12 row_mask:0xf bank_mask:0xf
  v_dot2c_f32_bf16_dpp v14, v32, v115 row_newbcast:12 row_mask:0xf bank_mask:0xf
  v_dot2c_f32_bf16_dpp v15, v33, v115 row_newbcast:12 row_mask:0xf bank_mask:0xf
  buffer_load_dwordx4 v[160:163], v1, s[44:47], s62 offen offset:0 nt
  buffer_load_dwordx4 v[164:167], v1, s[44:47], s62 offen offset:1024 nt
  s_waitcnt vmcnt(12)
  v_dot2c_f32_bf16_dpp v8, v32, v116 row_newbcast:13 row_mask:0xf bank_mask:0xf
  v_dot2c_f32_bf16_dpp v9, v33, v116 row_newbcast:13 row_mask:0xf bank_mask:0xf
  v_dot2c_f32_bf16_dpp v10, v32, v117 row_newbcast:13 row_mask:0xf bank_mask:0xf
  v_dot2c_f32_bf16_dpp v11, v33, v117 row_newbcast:13 row_mask:0xf bank_mask:0xf
  v_dot2c_f32_bf16_dpp v12, v32, v118 row_newbcast:13 row_mask:0xf bank_mask:0xf
  v_dot2c_f32_bf16_dpp v13, v33, v118 row_newbcast:13 row_mask:0xf bank_mask:0xf
  v_dot2c_f32_bf16_dpp v14, v32, v119 row_newbcast:13 row_mask:0xf bank_mask:0xf
  v_dot2c_f32_bf16_dpp v15, v33, v119 row_newbcast:13 row_mask:0xf bank_mask:0xf
  buffer_load_dwordx4 v[168:171], v1, s[44:47], s62 offen offset:2048 nt
  buffer_load_dwordx4 v[172:175], v1, s[44:47], s62 offen offset:3072 nt
  s_waitcnt vmcnt(13)
  v_dot2c_f32_bf16_dpp v8, v32, v120 row_newbcast:14 row_mask:0xf bank_mask:0xf
  v_dot2c_f32_bf16_dpp v9, v33, v120 row_newbcast:14 row_mask:0xf bank_mask:0xf
  v_dot2c_f32_bf16_dpp v10, v32, v121 row_newbcast:14 row_mask:0xf bank_mask:0xf
  v_dot2c_f32_bf16_dpp v11, v33, v121 row_newbcast:14 row_mask:0xf bank_mask:0xf
  v_dot2c_f32_bf16_dpp v12, v32, v122 row_newbcast:14 row_mask:0xf bank_mask:0xf
  v_dot2c_f32_bf16_dpp v13, v33, v122 row_newbcast:14 row_mask:0xf bank_mask:0xf
  v_dot2c_f32_bf16_dpp v14, v32, v123 row_newbcast:14 row_mask:0xf bank_mask:0xf
  v_dot2c_f32_bf16_dpp v15, v33, v123 row_newbcast:14 row_mask:0xf bank_mask:0xf
  buffer_load_dwordx4 v[176:179], v1, s[44:47], s63 offen offset:0 nt
  buffer_load_dwordx4 v[180:183], v1, s[44:47], s63 offen offset:1024 nt
  s_waitcnt vmcnt(14)
  v_dot2c_f32_bf16_dpp v8, v32, v124 row_newbcast:15 row_mask:0xf bank_mask:0xf
  v_dot2c_f32_bf16_dpp v9, v33, v124 row_newbcast:15 row_mask:0xf bank_mask:0xf
  v_dot2c_f32_bf16_dpp v10, v32, v125 row_newbcast:15 row_mask:0xf bank_mask:0xf
  v_dot2c_f32_bf16_dpp v11, v33, v125 row_newbcast:15 row_mask:0xf bank_mask:0xf
  v_dot2c_f32_bf16_dpp v12, v32, v126 row_newbcast:15 row_mask:0xf bank_mask:0xf
  v_dot2c_f32_bf16_dpp v13, v33, v126 row_newbcast:15 row_mask:0xf bank_mask:0xf
  v_dot2c_f32_bf16_dpp v14, v32, v127 row_newbcast:15 row_mask:0xf bank_mask:0xf
  v_dot2c_f32_bf16_dpp v15, v33, v127 row_newbcast:15 row_mask:0xf bank_mask:0xf
  buffer_load_dwordx4 v[184:187], v1, s[44:47], s63 offen offset:2048 nt
  buffer_load_dwordx4 v[188:191], v1, s[44:47], s63 offen offset:3072 nt
  s_waitcnt vmcnt(15)
  v_dot2c_f32_bf16_dpp v8, v34, v128 row_newbcast:0 row_mask:0xf bank_mask:0xf
  v_dot2c_f32_bf16_dpp v9, v35, v128 row_newbcast:0 row_mask:0xf bank_mask:0xf
  v_dot2c_f32_bf16_dpp v10, v34, v129 row_newbcast:0 row_mask:0xf bank_mask:0xf
  v_dot2c_f32_bf16_dpp v11, v35, v129 row_newbcast:0 row_mask:0xf bank_mask:0xf
  v_dot2c_f32_bf16_dpp v12, v34, v130 row_newbcast:0 row_mask:0xf bank_mask:0xf
  v_dot2c_f32_bf16_dpp v13, v35, v130 row_newbcast:0 row_mask:0xf bank_mask:0xf
  v_dot2c_f32_bf16_dpp v14, v34, v131 row_newbcast:0 row_mask:0xf bank_mask:0xf
  v_dot2c_f32_bf16_dpp v15, v35, v131 row_newbcast:0 row_mask:0xf bank_mask:0xf
  s_mov_b64 exec, 1
  ds_add_u32 v61, v62 offset:8
  s_mov_b64 exec, -1
  s_waitcnt vmcnt(14)
  v_dot2c_f32_bf16_dpp v8, v34, v132 row_newbcast:1 row_mask:0xf bank_mask:0xf
  v_dot2c_f32_bf16_dpp v9, v35, v132 row_newbcast:1 row_mask:0xf bank_mask:0xf
  v_dot2c_f32_bf16_dpp v10, v34, v133 row_newbcast:1 row_mask:0xf bank_mask:0xf
  v_dot2c_f32_bf16_dpp v11, v35, v133 row_newbcast:1 row_mask:0xf bank_mask:0xf
  v_dot2c_f32_bf16_dpp v12, v34, v134 row_newbcast:1 row_mask:0xf bank_mask:0xf
  v_dot2c_f32_bf16_dpp v13, v35, v134 row_newbcast:1 row_mask:0xf bank_mask:0xf
  v_dot2c_f32_bf16_dpp v14, v34, v135 row_newbcast:1 row_mask:0xf bank_mask:0xf
  v_dot2c_f32_bf16_dpp v15, v35, v135 row_newbcast:1 row_mask:0xf bank_mask:0xf
  s_waitcnt vmcnt(13)
  v_dot2c_f32_bf16_dpp v8, v34, v136 row_newbcast:2 row_mask:0xf bank_mask:0xf
  v_dot2c_f32_bf16_dpp v9, v35, v136 row_newbcast:2 row_mask:0xf bank_mask:0xf
  v_dot2c_f32_bf16_dpp v10, v34, v137 row_newbcast:2 row_mask:0xf bank_mask:0xf
  v_dot2c_f32_bf16_dpp v11, v35, v137 row_newbcast:2 row_mask:0xf bank_mask:0xf
  v_dot2c_f32_bf16_dpp v12, v34, v138 row_newbcast:2 row_mask:0xf bank_mask:0xf
  v_dot2c_f32_bf16_dpp v13, v35, v138 row_newbcast:2 row_mask:0xf bank_mask:0xf
  v_dot2c_f32_bf16_dpp v14, v34, v139 row_newbcast:2 row_mask:0xf bank_mask:0xf
  v_dot2c_f32_bf16_dpp v15, v35, v139 row_newbcast:2 row_mask:0xf bank_mask:0xf
  s_waitcnt vmcnt(12)
  v_dot2c_f32_bf16_dpp v8, v34, v140 row_newbcast:3 row_mask:0xf bank_mask:0xf
  v_dot2c_f32_bf16_dpp v9, v35, v140 row_newbcast:3 row_mask:0xf bank_mask:0xf
  v_dot2c_f32_bf16_dpp v10, v34, v141 row_newbcast:3 row_mask:0xf bank_mask:0xf
  v_dot2c_f32_bf16_dpp v11, v35, v141 row_newbcast:3 row_mask:0xf bank_mask:0xf
  v_dot2c_f32_bf16_dpp v12, v34, v142 row_newbcast:3 row_mask:0xf bank_mask:0xf
  v_dot2c_f32_bf16_dpp v13, v35, v142 row_newbcast:3 row_mask:0xf bank_mask:0xf
  v_dot2c_f32_bf16_dpp v14, v34, v143 row_newbcast:3 row_mask:0xf bank_mask:0xf
  v_dot2c_f32_bf16_dpp v15, v35, v143 row_newbcast:3 row_mask:0xf bank_mask:0xf
  s_waitcnt vmcnt(11)
  v_dot2c_f32_bf16_dpp v8, v34, v144 row_newbcast:4 row_mask:0xf bank_mask:0xf
  v_dot2c_f32_bf16_dpp v9, v35, v144 row_newbcast:4 row_mask:0xf bank_mask:0xf
  v_dot2c_f32_bf16_dpp v10, v34, v145 row_newbcast:4 row_mask:0xf bank_mask:0xf
  v_dot2c_f32_bf16_dpp v11, v35, v145 row_newbcast:4 row_mask:0xf bank_mask:0xf
  v_dot2c_f32_bf16_dpp v12, v34, v146 row_newbcast:4 row_mask:0xf bank_mask:0xf
  v_dot2c_f32_bf16_dpp v13, v35, v146 row_newbcast:4 row_mask:0xf bank_mask:0xf
  v_dot2c_f32_bf16_dpp v14, v34, v147 row_newbcast:4 row_mask:0xf bank_mask:0xf
  v_dot2c_f32_bf16_dpp v15, v35, v147 row_newbcast:4 row_mask:0xf bank_mask:0xf
  s_waitcnt vmcnt(10)
  v_dot2c_f32_bf16_dpp v8, v34, v148 row_newbcast:5 row_mask:0xf bank_mask:0xf
  v_dot2c_f32_bf16_dpp v9, v35, v148 row_newbcast:5 row_mask:0xf bank_mask:0xf
  v_dot2c_f32_bf16_dpp v10, v34, v149 row_newbcast:5 row_mask:0xf bank_mask:0xf
  v_dot2c_f32_bf16_dpp v11, v35, v149 row_newbcast:5 row_mask:0xf bank_mask:0xf
  v_dot2c_f32_bf16_dpp v12, v34, v150 row_newbcast:5 row_mask:0xf bank_mask:0xf
  v_dot2c_f32_bf16_dpp v13, v35, v150 row_newbcast:5 row_mask:0xf bank_mask:0xf
  v_dot2c_f32_bf16_dpp v14, v34, v151 row_newbcast:5 row_mask:0xf bank_mask:0xf
  v_dot2c_f32_bf16_dpp v15, v35, v151 row_newbcast:5 row_mask:0xf bank_mask:0xf
  s_waitcnt vmcnt(9)
  v_dot2c_f32_bf16_dpp v8, v34, v152 row_newbcast:6 row_mask:0xf bank_mask:0xf
  v_dot2c_f32_bf16_dpp v9, v35, v152 row_newbcast:6 row_mask:0xf bank_mask:0xf
  v_dot2c_f32_bf16_dpp v10, v34, v153 row_newbcast:6 row_mask:0xf bank_mask:0xf
  v_dot2c_f32_bf16_dpp v11, v35, v153 row_newbcast:6 row_mask:0xf bank_mask:0xf
  v_dot2c_f32_bf16_dpp v12, v34, v154 row_newbcast:6 row_mask:0xf bank_mask:0xf
  v_dot2c_f32_bf16_dpp v13, v35, v154 row_newbcast:6 row_mask:0xf bank_mask:0xf
  v_dot2c_f32_bf16_dpp v14, v34, v155 row_newbcast:6 row_mask:0xf bank_mask:0xf
  v_dot2c_f32_bf16_dpp v15, v35, v155 row_newbcast:6 row_mask:0xf bank_mask:0xf
  s_waitcnt vmcnt(8)
  v_dot2c_f32_bf16_dpp v8, v34, v156 row_newbcast:7 row_mask:0xf bank_mask:0xf
  v_dot2c_f32_bf16_dpp v9, v35, v156 row_newbcast:7 row_mask:0xf bank_mask:0xf
  v_dot2c_f32_bf16_dpp v10, v34, v157 row_newbcast:7 row_mask:0xf bank_mask:0xf
  v_dot2c_f32_bf16_dpp v11, v35, v157 row_newbcast:7 row_mask:0xf bank_mask:0xf
  v_dot2c_f32_bf16_dpp v12, v34, v158 row_newbcast:7 row_mask:0xf bank_mask:0xf
  v_dot2c_f32_bf16_dpp v13, v35, v158 row_newbcast:7 row_mask:0xf bank_mask:0xf
  v_dot2c_f32_bf16_dpp v14, v34, v159 row_newbcast:7 row_mask:0xf bank_mask:0xf
  v_dot2c_f32_bf16_dpp v15, v35, v159 row_newbcast:7 row_mask:0xf bank_mask:0xf
  s_waitcnt vmcnt(7)
  v_dot2c_f32_bf16_dpp v8, v34, v160 row_newbcast:8 row_mask:0xf bank_mask:0xf
  v_dot2c_f32_bf16_dpp v9, v35, v160 row_newbcast:8 row_mask:0xf bank_mask:0xf
  v_dot2c_f32_bf16_dpp v10, v34, v161 row_newbcast:8 row_mask:0xf bank_mask:0xf
  v_dot2c_f32_bf16_dpp v11, v35, v161 row_newbcast:8 row_mask:0xf bank_mask:0xf
  v_dot2c_f32_bf16_dpp v12, v34, v162 row_newbcast:8 row_mask:0xf bank_mask:0xf
  v_dot2c_f32_bf16_dpp v13, v35, v162 row_newbcast:8 row_mask:0xf bank_mask:0xf
  v_dot2c_f32_bf16_dpp v14, v34, v163 row_newbcast:8 row_mask:0xf bank_mask:0xf
  v_dot2c_f32_bf16_dpp v15, v35, v163 row_newbcast:8 row_mask:0xf bank_mask:0xf
  s_waitcnt vmcnt(6)
  v_dot2c_f32_bf16_dpp v8, v34, v164 row_newbcast:9 row_mask:0xf bank_mask:0xf
  v_dot2c_f32_bf16_dpp v9, v35, v164 row_newbcast:9 row_mask:0xf bank_mask:0xf
  v_dot2c_f32_bf16_dpp v10, v34, v165 row_newbcast:9 row_mask:0xf bank_mask:0xf
  v_dot2c_f32_bf16_dpp v11, v35, v165 row_newbcast:9 row_mask:0xf bank_mask:0xf
  v_dot2c_f32_bf16_dpp v12, v34, v166 row_newbcast:9 row_mask:0xf bank_mask:0xf
  v_dot2c_f32_bf16_dpp v13, v35, v166 row_newbcast:9 row_mask:0xf bank_mask:0xf
  v_dot2c_f32_bf16_dpp v14, v34, v167 row_newbcast:9 row_mask:0xf bank_mask:0xf
  v_dot2c_f32_bf16_dpp v15, v35, v167 row_newbcast:9 row_mask:0xf bank_mask:0xf
  s_waitcnt vmcnt(5)
  v_dot2c_f32_bf16_dpp v8, v34, v168 row_newbcast:10 row_mask:0xf bank_mask:0xf
  v_dot2c_f32_bf16_dpp v9, v35, v168 row_newbcast:10 row_mask:0xf bank_mask:0xf
  v_dot2c_f32_bf16_dpp v10, v34, v169 row_newbcast:10 row_mask:0xf bank_mask:0xf
  v_dot2c_f32_bf16_dpp v11, v35, v169 row_newbcast:10 row_mask:0xf bank_mask:0xf
  v_dot2c_f32_bf16_dpp v12, v34, v170 row_newbcast:10 row_mask:0xf bank_mask:0xf
  v_dot2c_f32_bf16_dpp v13, v35, v170 row_newbcast:10 row_mask:0xf bank_mask:0xf
  v_dot2c_f32_bf16_dpp v14, v34, v171 row_newbcast:10 row_mask:0xf bank_mask:0xf
  v_dot2c_f32_bf16_dpp v15, v35, v171 row_newbcast:10 row_mask:0xf bank_mask:0xf
  s_waitcnt vmcnt(4)
  v_dot2c_f32_bf16_dpp v8, v34, v172 row_newbcast:11 row_mask:0xf bank_mask:0xf
  v_dot2c_f32_bf16_dpp v9, v35, v172 row_newbcast:11 row_mask:0xf bank_mask:0xf
  v_dot2c_f32_bf16_dpp v10, v34, v173 row_newbcast:11 row_mask:0xf bank_mask:0xf
  v_dot2c_f32_bf16_dpp v11, v35, v173 row_newbcast:11 row_mask:0xf bank_mask:0xf
  v_dot2c_f32_bf16_dpp v12, v34, v174 row_newbcast:11 row_mask:0xf bank_mask:0xf
  v_dot2c_f32_bf16_dpp v13, v35, v174 row_newbcast:11 row_mask:0xf bank_mask:0xf
  v_dot2c_f32_bf16_dpp v14, v34, v175 row_newbcast:11 row_mask:0xf bank_mask:0xf
  v_dot2c_f32_bf16_dpp v15, v35, v175 row_newbcast:11 row_mask:0xf bank_mask:0xf
  s_waitcnt vmcnt(3)
  v_dot2c_f32_bf16_dpp v8, v34, v176 row_newbcast:12 row_mask:0xf bank_mask:0xf
  v_dot2c_f32_bf16_dpp v9, v35, v176 row_newbcast:12 row_mask:0xf bank_mask:0xf
  v_dot2c_f32_bf16_dpp v10, v34, v177 row_newbcast:12 row_mask:0xf bank_mask:0xf
  v_dot2c_f32_bf16_dpp v11, v35, v177 row_newbcast:12 row_mask:0xf bank_mask:0xf
  v_dot2c_f32_bf16_dpp v12, v34, v178 row_newbcast:12 row_mask:0xf bank_mask:0xf
  v_dot2c_f32_bf16_dpp v13, v35, v178 row_newbcast:12 row_mask:0xf bank_mask:0xf
  v_dot2c_f32_bf16_dpp v14, v34, v179 row_newbcast:12 row_mask:0xf bank_mask:0xf
  v_dot2c_f32_bf16_dpp v15, v35, v179 row_newbcast:12 row_mask:0xf bank_mask:0xf
  s_waitcnt vmcnt(2)
  v_dot2c_f32_bf16_dpp v8, v34, v180 row_newbcast:13 row_mask:0xf bank_mask:0xf
  v_dot2c_f32_bf16_dpp v9, v35, v180 row_newbcast:13 row_mask:0xf bank_mask:0xf
  v_dot2c_f32_bf16_dpp v10, v34, v181 row_newbcast:13 row_mask:0xf bank_mask:0xf
  v_dot2c_f32_bf16_dpp v11, v35, v181 row_newbcast:13 row_mask:0xf bank_mask:0xf
  v_dot2c_f32_bf16_dpp v12, v34, v182 row_newbcast:13 row_mask:0xf bank_mask:0xf
  v_dot2c_f32_bf16_dpp v13, v35, v182 row_newbcast:13 row_mask:0xf bank_mask:0xf
  v_dot2c_f32_bf16_dpp v14, v34, v183 row_newbcast:13 row_mask:0xf bank_mask:0xf
  v_dot2c_f32_bf16_dpp v15, v35, v183 row_newbcast:13 row_mask:0xf bank_mask:0xf
  s_waitcnt vmcnt(1)
  v_dot2c_f32_bf16_dpp v8, v34, v184 row_newbcast:14 row_mask:0xf bank_mask:0xf
  v_dot2c_f32_bf16_dpp v9, v35, v184 row_newbcast:14 row_mask:0xf bank_mask:0xf
  v_dot2c_f32_bf16_dpp v10, v34, v185 row_newbcast:14 row_mask:0xf bank_mask:0xf
  v_dot2c_f32_bf16_dpp v11, v35, v185 row_newbcast:14 row_mask:0xf bank_mask:0xf
  v_dot2c_f32_bf16_dpp v12, v34, v186 row_newbcast:14 row_mask:0xf bank_mask:0xf
  v_dot2c_f32_bf16_dpp v13, v35, v186 row_newbcast:14 row_mask:0xf bank_mask:0xf
  v_dot2c_f32_bf16_dpp v14, v34, v187 row_newbcast:14 row_mask:0xf bank_mask:0xf
  v_dot2c_f32_bf16_dpp v15, v35, v187 row_newbcast:14 row_mask:0xf bank_mask:0xf
  s_waitcnt vmcnt(0)
  v_dot2c_f32_bf16_dpp v8, v34, v188 row_newbcast:15 row_mask:0xf bank_mask:0xf
  v_dot2c_f32_bf16_dpp v9, v35, v188 row_newbcast:15 row_mask:0xf bank_mask:0xf
  v_dot2c_f32_bf16_dpp v10, v34, v189 row_newbcast:15 row_mask:0xf bank_mask:0xf
  v_dot2c_f32_bf16_dpp v11, v35, v189 row_newbcast:15 row_mask:0xf bank_mask:0xf
  v_dot2c_f32_bf16_dpp v12, v34, v190 row_newbcast:15 row_mask:0xf bank_mask:0xf
  v_dot2c_f32_bf16_dpp v13, v35, v190 row_newbcast:15 row_mask:0xf bank_mask:0xf
  v_dot2c_f32_bf16_dpp v14, v34, v191 row_newbcast:15 row_mask:0xf bank_mask:0xf
  v_dot2c_f32_bf16_dpp v15, v35, v191 row_newbcast:15 row_mask:0xf bank_mask:0xf
  v_cvt_pk_bf16_f32 v16, v8, v9
  v_cvt_pk_bf16_f32 v17, v10, v11
  v_cvt_pk_bf16_f32 v18, v12, v13
  v_cvt_pk_bf16_f32 v19, v14, v15
  v_lshrrev_b32 v3, 5, v0
  v_mul_u32_u24 v3, 528, v3
  v_and_b32 v2, 31, v0
  v_lshl_add_u32 v3, v2, 4, v3
  s_mul_i32 s35, s26, 1056
  v_add_u32 v3, s35, v3
  ds_write_b128 v3, v[16:19] offset:8192
  s_waitcnt lgkmcnt(0)
  s_barrier
  s_endpgm
L_helper:
  s_sub_u32 s29, s26, 4
  v_cmp_gt_u32 s[38:39], 56, v0
  v_lshlrev_b32 v1, 4, v0
  v_mov_b32 v2, 0x7ffffff0
  v_cndmask_b32 v1, v2, v1, s[38:39]
  s_mul_i32 s35, s29, 1792
  s_lshl_b32 s33, s29, 14
  s_add_u32 s33, s33, 33792
  s_waitcnt lgkmcnt(0)
  s_mov_b32 s44, s4
  s_mov_b32 s45, s5
  s_mov_b32 s46, 7168
  s_mov_b32 s47, 0x20000
  s_mov_b32 s73, s35
  s_mov_b32 s69, 0
  s_and_b32 s86, s2, 1
  s_bfe_u32 s87, s2, 0x20001
  s_bfe_u32 s88, s2, 0x20003
  buffer_load_dwordx4 v[8:11], v1, s[44:47], s35 offen nt
  buffer_load_dwordx4 v[12:15], v1, s[44:47], s35 offen offset:896 nt
L_h_nox:
  s_add_u32 s52, s24, 0
  s_addc_u32 s53, s25, 0
  s_mov_b32 s54, 4194304
  s_mov_b32 s55, 0x20000
  s_mov_b32 s51, 0x20000
  s_mov_b32 s64, 0
  s_cmp_eq_u32 s29, 0
  s_cbranch_scc1 L_h_rq
  s_cmp_lg_u32 s29, 1
  s_cbranch_scc1 L_h_nop
  s_cmp_eq_u32 s86, 0
  s_cbranch_scc1 L_h_nop
  s_cmp_ge_u32 s27, 7
  s_cbranch_scc1 L_h_nop
  s_mul_i32 s66, s87, 7
  s_add_u32 s66, s66, s27
  s_mov_b32 s37, s88
  s_lshl_b32 s35, s66, 2
  s_add_u32 s35, s35, s37
  s_lshl_b32 s36, s35, 5
  s_add_u32 s48, s16, s36
  s_addc_u32 s49, s17, 0
  s_sub_u32 s50, 1605632, s36
  s_mov_b32 s65, 3584
  s_lshl_b32 s66, s66, 11
  s_lshl_b32 s37, s37, 6
  s_add_u32 s66, s66, s37
  s_add_u32 s66, s66, 2097152
  s_mov_b32 s67, 256
  s_branch L_h_dma
L_h_rq:
  s_lshl_b32 s35, s27, 1
  s_and_b32 s36, s30, 1
  s_add_u32 s35, s35, s36
  s_mov_b32 s66, s28
  s_lshl_b32 s36, s66, 9
  s_lshl_b32 s37, s35, 5
  s_add_u32 s36, s36, s37
  s_add_u32 s48, s10, s36
  s_addc_u32 s49, s11, 0
  s_sub_u32 s50, 3670016, s36
  s_mov_b32 s65, 8192
  s_lshl_b32 s66, s66, 10
  s_lshl_b32 s37, s35, 6
  s_add_u32 s66, s66, s37
  s_add_u32 s66, s66, 1048576
  s_mov_b32 s67, 16384
L_h_dma:
  s_mov_b32 s64, 1
  v_lshrrev_b32 v4, 1, v0
  v_mul_lo_u32 v4, s65, v4
  v_and_b32 v5, 1, v0
  v_lshl_add_u32 v4, v5, 4, v4
  s_lshl_b32 s36, s65, 5
  s_mov_b32 s37, 0
  s_mov_b32 m0, s33
  s_cmp_eq_u32 s29, 1
  s_cbranch_scc1 L_h_nop
  buffer_load_dwordx4 v4, s[48:51], s37 offen nt lds
  s_add_u32 m0, m0, 1024
  s_add_u32 s37, s37, s36
  buffer_load_dwordx4 v4, s[48:51], s37 offen nt lds
  s_add_u32 m0, m0, 1024
  s_add_u32 s37, s37, s36
  buffer_load_dwordx4 v4, s[48:51], s37 offen nt lds
  s_add_u32 m0, m0, 1024
  s_add_u32 s37, s37, s36
  buffer_load_dwordx4 v4, s[48:51], s37 offen nt lds
  s_add_u32 m0, m0, 1024
  s_add_u32 s37, s37, s36
  buffer_load_dwordx4 v4, s[48:51], s37 offen nt lds
  s_add_u32 m0, m0, 1024
  s_add_u32 s37, s37, s36
  buffer_load_dwordx4 v4, s[48:51], s37 offen nt lds
  s_add_u32 m0, m0, 1024
  s_add_u32 s37, s37, s36
  buffer_load_dwordx4 v4, s[48:51], s37 offen nt lds
  s_add_u32 m0, m0, 1024
  s_add_u32 s37, s37, s36
  buffer_load_dwordx4 v4, s[48:51], s37 offen nt lds
  s_add_u32 m0, m0, 1024
  s_add_u32 s37, s37, s36
  buffer_load_dwordx4 v4, s[48:51], s37 offen nt lds
  s_add_u32 m0, m0, 1024
  s_add_u32 s37, s37, s36
  buffer_load_dwordx4 v4, s[48:51], s37 offen nt lds
  s_add_u32 m0, m0, 1024
  s_add_u32 s37, s37, s36
  buffer_load_dwordx4 v4, s[48:51], s37 offen nt lds
  s_add_u32 m0, m0, 1024
  s_add_u32 s37, s37, s36
  buffer_load_dwordx4 v4, s[48:51], s37 offen nt lds
  s_add_u32 m0, m0, 1024
  s_add_u32 s37, s37, s36
  buffer_load_dwordx4 v4, s[48:51], s37 offen nt lds
  s_add_u32 m0, m0, 1024
  s_add_u32 s37, s37, s36
  buffer_load_dwordx4 v4, s[48:51], s37 offen nt lds
  s_barrier
  s_waitcnt vmcnt(14)
  s_branch L_h_ln
L_h_nop:
  s_barrier
  s_waitcnt vmcnt(0)
L_h_ln:
  v_lshlrev_b32 v16, 16, v8
  v_and_b32 v17, 0xffff0000, v8
  v_lshlrev_b32 v18, 16, v9
  v_and_b32 v19, 0xffff0000, v9
  v_lshlrev_b32 v20, 16, v10
  v_and_b32 v21, 0xffff0000, v10
  v_lshlrev_b32 v22, 16, v11
  v_and_b32 v23, 0xffff0000, v11
  v_lshlrev_b32 v24, 16, v12
  v_and_b32 v25, 0xffff0000, v12
  v_lshlrev_b32 v26, 16, v13
  v_and_b32 v27, 0xffff0000, v13
  v_lshlrev_b32 v28, 16, v14
  v_and_b32 v29, 0xffff0000, v14
  v_lshlrev_b32 v30, 16, v15
  v_and_b32 v31, 0xffff0000, v15
  v_add_f32 v32, v16, v17
  v_add_f32 v32, v32, v18
  v_add_f32 v32, v32, v19
  v_add_f32 v32, v32, v20
  v_add_f32 v32, v32, v21
  v_add_f32 v32, v32, v22
  v_add_f32 v32, v32, v23
  v_add_f32 v33, v24, v25
  v_add_f32 v33, v33, v26
  v_add_f32 v33, v33, v27
  v_add_f32 v33, v33, v28
  v_add_f32 v33, v33, v29
  v_add_f32 v33, v33, v30
  v_add_f32 v33, v33, v31
  v_add_f32_dpp v32, v32, v32 row_ror:8 row_mask:0xf bank_mask:0xf
  s_nop 1
  v_add_f32_dpp v32, v32, v32 row_ror:4 row_mask:0xf bank_mask:0xf
  s_nop 1
  v_add_f32_dpp v32, v32, v32 row_ror:2 row_mask:0xf bank_mask:0xf
  s_nop 1
  v_add_f32_dpp v32, v32, v32 row_ror:1 row_mask:0xf bank_mask:0xf
  v_mov_b32 v34, v32
  s_nop 1
  v_permlane16_swap_b32 v32, v34
  v_add_f32 v32, v32, v34
  v_mov_b32 v34, v32
  s_nop 1
  v_permlane32_swap_b32 v32, v34
  v_add_f32 v32, v32, v34
  v_add_f32_dpp v33, v33, v33 row_ror:8 row_mask:0xf bank_mask:0xf
  s_nop 1
  v_add_f32_dpp v33, v33, v33 row_ror:4 row_mask:0xf bank_mask:0xf
  s_nop 1
  v_add_f32_dpp v33, v33, v33 row_ror:2 row_mask:0xf bank_mask:0xf
  s_nop 1
  v_add_f32_dpp v33, v33, v33 row_ror:1 row_mask:0xf bank_mask:0xf
  v_mov_b32 v35, v33
  s_nop 1
  v_permlane16_swap_b32 v33, v35
  v_add_f32 v33, v33, v35
  v_mov_b32 v35, v33
  s_nop 1
  v_permlane32_swap_b32 v33, v35
  v_add_f32 v33, v33, v35
  s_mov_b32 s35, 0x3b124925
  v_mul_f32 v32, s35, v32
  v_mul_f32 v33, s35, v33
  v_mov_b32 v34, 0
  v_sub_f32 v36, v16, v32
  v_fmac_f32 v34, v36, v36
  v_sub_f32 v36, v17, v32
  v_fmac_f32 v34, v36, v36
  v_sub_f32 v36, v18, v32
  v_fmac_f32 v34, v36, v36
  v_sub_f32 v36, v19, v32
  v_fmac_f32 v34, v36, v36
  v_sub_f32 v36, v20, v32
  v_fmac_f32 v34, v36, v36
  v_sub_f32 v36, v21, v32
  v_fmac_f32 v34, v36, v36
  v_sub_f32 v36, v22, v32
  v_fmac_f32 v34, v36, v36
  v_sub_f32 v36, v23, v32
  v_fmac_f32 v34, v36, v36
  v_cndmask_b32 v34, v61, v34, s[38:39]
  v_mov_b32 v35, 0
  v_sub_f32 v36, v24, v33
  v_fmac_f32 v35, v36, v36
  v_sub_f32 v36, v25, v33
  v_fmac_f32 v35, v36, v36
  v_sub_f32 v36, v26, v33
  v_fmac_f32 v35, v36, v36
  v_sub_f32 v36, v27, v33
  v_fmac_f32 v35, v36, v36
  v_sub_f32 v36, v28, v33
  v_fmac_f32 v35, v36, v36
  v_sub_f32 v36, v29, v33
  v_fmac_f32 v35, v36, v36
  v_sub_f32 v36, v30, v33
  v_fmac_f32 v35, v36, v36
  v_sub_f32 v36, v31, v33
  v_fmac_f32 v35, v36, v36
  v_cndmask_b32 v35, v61, v35, s[38:39]
  v_add_f32_dpp v34, v34, v34 row_ror:8 row_mask:0xf bank_mask:0xf
  s_nop 1
  v_add_f32_dpp v34, v34, v34 row_ror:4 row_mask:0xf bank_mask:0xf
  s_nop 1
  v_add_f32_dpp v34, v34, v34 row_ror:2 row_mask:0xf bank_mask:0xf
  s_nop 1
  v_add_f32_dpp v34, v34, v34 row_ror:1 row_mask:0xf bank_mask:0xf
  v_mov_b32 v36, v34
  s_nop 1
  v_permlane16_swap_b32 v34, v36
  v_add_f32 v34, v34, v36
  v_mov_b32 v36, v34
  s_nop 1
  v_permlane32_swap_b32 v34, v36
  v_add_f32 v34, v34, v36
  v_add_f32_dpp v35, v35, v35 row_ror:8 row_mask:0xf bank_mask:0xf
  s_nop 1
  v_add_f32_dpp v35, v35, v35 row_ror:4 row_mask:0xf bank_mask:0xf
  s_nop 1
  v_add_f32_dpp v35, v35, v35 row_ror:2 row_mask:0xf bank_mask:0xf
  s_nop 1
  v_add_f32_dpp v35, v35, v35 row_ror:1 row_mask:0xf bank_mask:0xf
  v_mov_b32 v37, v35
  s_nop 1
  v_permlane16_swap_b32 v35, v37
  v_add_f32 v35, v35, v37
  v_mov_b32 v37, v35
  s_nop 1
  v_permlane32_swap_b32 v35, v37
  v_add_f32 v35, v35, v37
  v_mul_f32 v34, s35, v34
  v_cvt_pk_bf16_f32 v34, v34, v34
  v_and_b32 v34, 0xffff0000, v34
  v_cvt_pk_bf16_f32 v32, v32, v32
  v_and_b32 v32, 0xffff0000, v32
  v_add_f32 v34, 0x3727c5ac, v34
  v_cvt_pk_bf16_f32 v34, v34, v34
  v_and_b32 v34, 0xffff0000, v34
  v_sqrt_f32 v34, v34
  s_nop 0
  v_cvt_pk_bf16_f32 v34, v34, v34
  v_and_b32 v34, 0xffff0000, v34
  v_rcp_f32 v36, v34
  v_mul_f32 v35, s35, v35
  v_cvt_pk_bf16_f32 v35, v35, v35
  v_and_b32 v35, 0xffff0000, v35
  v_cvt_pk_bf16_f32 v33, v33, v33
  v_and_b32 v33, 0xffff0000, v33
  v_add_f32 v35, 0x3727c5ac, v35
  v_cvt_pk_bf16_f32 v35, v35, v35
  v_and_b32 v35, 0xffff0000, v35
  v_sqrt_f32 v35, v35
  s_nop 0
  v_cvt_pk_bf16_f32 v35, v35, v35
  v_and_b32 v35, 0xffff0000, v35
  v_rcp_f32 v37, v35
  v_sub_f32 v16, v16, v32
  v_sub_f32 v17, v17, v32
  v_sub_f32 v18, v18, v32
  v_sub_f32 v19, v19, v32
  v_sub_f32 v20, v20, v32
  v_sub_f32 v21, v21, v32
  v_sub_f32 v22, v22, v32
  v_sub_f32 v23, v23, v32
  v_cvt_pk_bf16_f32 v38, v16, v17
  v_lshlrev_b32 v16, 16, v38
  v_and_b32 v17, 0xffff0000, v38
  v_cvt_pk_bf16_f32 v38, v18, v19
  v_lshlrev_b32 v18, 16, v38
  v_and_b32 v19, 0xffff0000, v38
  v_cvt_pk_bf16_f32 v38, v20, v21
  v_lshlrev_b32 v20, 16, v38
  v_and_b32 v21, 0xffff0000, v38
  v_cvt_pk_bf16_f32 v38, v22, v23
  v_lshlrev_b32 v22, 16, v38
  v_and_b32 v23, 0xffff0000, v38
  v_mul_f32 v38, v16, v36
  v_fma_f32 v39, -v38, v34, v16
  v_fma_f32 v16, v39, v36, v38
  v_mul_f32 v38, v17, v36
  v_fma_f32 v39, -v38, v34, v17
  v_fma_f32 v17, v39, v36, v38
  v_mul_f32 v38, v18, v36
  v_fma_f32 v39, -v38, v34, v18
  v_fma_f32 v18, v39, v36, v38
  v_mul_f32 v38, v19, v36
  v_fma_f32 v39, -v38, v34, v19
  v_fma_f32 v19, v39, v36, v38
  v_mul_f32 v38, v20, v36
  v_fma_f32 v39, -v38, v34, v20
  v_fma_f32 v20, v39, v36, v38
  v_mul_f32 v38, v21, v36
  v_fma_f32 v39, -v38, v34, v21
  v_fma_f32 v21, v39, v36, v38
  v_mul_f32 v38, v22, v36
  v_fma_f32 v39, -v38, v34, v22
  v_fma_f32 v22, v39, v36, v38
  v_mul_f32 v38, v23, v36
  v_fma_f32 v39, -v38, v34, v23
  v_fma_f32 v23, v39, v36, v38
  v_cvt_pk_bf16_f32 v8, v16, v17
  v_cvt_pk_bf16_f32 v9, v18, v19
  v_cvt_pk_bf16_f32 v10, v20, v21
  v_cvt_pk_bf16_f32 v11, v22, v23
  v_sub_f32 v24, v24, v33
  v_sub_f32 v25, v25, v33
  v_sub_f32 v26, v26, v33
  v_sub_f32 v27, v27, v33
  v_sub_f32 v28, v28, v33
  v_sub_f32 v29, v29, v33
  v_sub_f32 v30, v30, v33
  v_sub_f32 v31, v31, v33
  v_cvt_pk_bf16_f32 v38, v24, v25
  v_lshlrev_b32 v24, 16, v38
  v_and_b32 v25, 0xffff0000, v38
  v_cvt_pk_bf16_f32 v38, v26, v27
  v_lshlrev_b32 v26, 16, v38
  v_and_b32 v27, 0xffff0000, v38
  v_cvt_pk_bf16_f32 v38, v28, v29
  v_lshlrev_b32 v28, 16, v38
  v_and_b32 v29, 0xffff0000, v38
  v_cvt_pk_bf16_f32 v38, v30, v31
  v_lshlrev_b32 v30, 16, v38
  v_and_b32 v31, 0xffff0000, v38
  v_mul_f32 v38, v24, v37
  v_fma_f32 v39, -v38, v35, v24
  v_fma_f32 v24, v39, v37, v38
  v_mul_f32 v38, v25, v37
  v_fma_f32 v39, -v38, v35, v25
  v_fma_f32 v25, v39, v37, v38
  v_mul_f32 v38, v26, v37
  v_fma_f32 v39, -v38, v35, v26
  v_fma_f32 v26, v39, v37, v38
  v_mul_f32 v38, v27, v37
  v_fma_f32 v39, -v38, v35, v27
  v_fma_f32 v27, v39, v37, v38
  v_mul_f32 v38, v28, v37
  v_fma_f32 v39, -v38, v35, v28
  v_fma_f32 v28, v39, v37, v38
  v_mul_f32 v38, v29, v37
  v_fma_f32 v39, -v38, v35, v29
  v_fma_f32 v29, v39, v37, v38
  v_mul_f32 v38, v30, v37
  v_fma_f32 v39, -v38, v35, v30
  v_fma_f32 v30, v39, v37, v38
  v_mul_f32 v38, v31, v37
  v_fma_f32 v39, -v38, v35, v31
  v_fma_f32 v31, v39, v37, v38
  v_cvt_pk_bf16_f32 v12, v24, v25
  v_cvt_pk_bf16_f32 v13, v26, v27
  v_cvt_pk_bf16_f32 v14, v28, v29
  v_cvt_pk_bf16_f32 v15, v30, v31
  v_lshlrev_b32 v5, 4, v0
  v_add_u32 v5, s73, v5
  s_mov_b64 exec, s[38:39]
  ds_write_b128 v5, v[8:11] offset:1024
  ds_write_b128 v5, v[12:15] offset:1920
  s_mov_b64 exec, -1
  s_waitcnt lgkmcnt(0)
  s_mov_b64 exec, 1
  ds_add_u32 v61, v62 offset:0
  s_mov_b64 exec, -1
  s_sub_u32 s35, s29, s64
  s_cmp_ge_i32 s35, 2
  s_cbranch_scc1 L_h_ffdone
L_poll_3:
  ds_read_b32 v3, v61 offset:0
  s_waitcnt lgkmcnt(0)
  v_readfirstlane_b32 s36, v3
  s_cmp_eq_u32 s36, 4
  s_cbranch_scc1 L_pd_4
  s_sleep 1
  s_branch L_poll_3
L_pd_4:
  s_cmp_eq_u32 s64, 0
  s_cbranch_scc1 L_h_pdone
  s_cmp_lg_u32 s29, 1
  s_cbranch_scc1 L_h_dmad
  s_lshl_b32 s36, s65, 5
  s_mov_b32 s37, 0
  s_mov_b32 m0, s33
  s_nop 0
  buffer_load_dwordx4 v4, s[48:51], s37 offen nt lds
  s_add_u32 m0, m0, 1024
  s_add_u32 s37, s37, s36
  buffer_load_dwordx4 v4, s[48:51], s37 offen nt lds
  s_add_u32 m0, m0, 1024
  s_add_u32 s37, s37, s36
  buffer_load_dwordx4 v4, s[48:51], s37 offen nt lds
  s_add_u32 m0, m0, 1024
  s_add_u32 s37, s37, s36
  buffer_load_dwordx4 v4, s[48:51], s37 offen nt lds
  s_add_u32 m0, m0, 1024
  s_add_u32 s37, s37, s36
  buffer_load_dwordx4 v4, s[48:51], s37 offen nt lds
  s_add_u32 m0, m0, 1024
  s_add_u32 s37, s37, s36
  buffer_load_dwordx4 v4, s[48:51], s37 offen nt lds
  s_add_u32 m0, m0, 1024
  s_add_u32 s37, s37, s36
  buffer_load_dwordx4 v4, s[48:51], s37 offen nt lds
  s_add_u32 m0, m0, 1024
  s_add_u32 s37, s37, s36
  buffer_load_dwordx4 v4, s[48:51], s37 offen nt lds
  s_add_u32 m0, m0, 1024
  s_add_u32 s37, s37, s36
  buffer_load_dwordx4 v4, s[48:51], s37 offen nt lds
  s_add_u32 m0, m0, 1024
  s_add_u32 s37, s37, s36
  buffer_load_dwordx4 v4, s[48:51], s37 offen nt lds
  s_add_u32 m0, m0, 1024
  s_add_u32 s37, s37, s36
  buffer_load_dwordx4 v4, s[48:51], s37 offen nt lds
  s_add_u32 m0, m0, 1024
  s_add_u32 s37, s37, s36
  buffer_load_dwordx4 v4, s[48:51], s37 offen nt lds
  s_add_u32 m0, m0, 1024
  s_add_u32 s37, s37, s36
  buffer_load_dwordx4 v4, s[48:51], s37 offen nt lds
  s_add_u32 m0, m0, 1024
  s_add_u32 s37, s37, s36
  buffer_load_dwordx4 v4, s[48:51], s37 offen nt lds
L_h_dmad:
  v_and_b32 v7, 7, v0
  v_mul_u32_u24 v4, 896, v7
  v_lshrrev_b32 v5, 4, v0
  v_lshl_add_u32 v4, v5, 4, v4
  ds_read_b128 v[64:67], v4 offset:1024
  ds_read_b128 v[68:71], v4 offset:1088
  ds_read_b128 v[72:75], v4 offset:1152
  ds_read_b128 v[76:79], v4 offset:1216
  ds_read_b128 v[80:83], v4 offset:1280
  ds_read_b128 v[84:87], v4 offset:1344
  ds_read_b128 v[88:91], v4 offset:1408
  ds_read_b128 v[92:95], v4 offset:1472
  ds_read_b128 v[96:99], v4 offset:1536
  ds_read_b128 v[100:103], v4 offset:1600
  ds_read_b128 v[104:107], v4 offset:1664
  ds_read_b128 v[108:111], v4 offset:1728
  ds_read_b128 v[112:115], v4 offset:1792
  ds_read_b128 v[116:119], v4 offset:1856
  v_bfe_u32 v6, v0, 2, 2
  v_lshlrev_b32 v6, 5, v6
  v_and_b32 v3, 3, v0
  v_lshl_add_u32 v6, v3, 3, v6
  v_lshl_add_u32 v6, v5, 8, v6
  v_add_u32 v6, s33, v6
  v_mul_lo_u32 v7, s67, v7
  v_lshl_add_u32 v7, v5, 4, v7
  v_and_b32 v3, 8, v0
  v_cmp_eq_u32 vcc, 0, v3
  s_nop 1
  v_cndmask_b32 v7, v2, v7, vcc
  s_waitcnt lgkmcnt(0)
  s_waitcnt vmcnt(13)
  ds_read_b64_tr_b16 v[128:129], v6 offset:0
  ds_read_b64_tr_b16 v[130:131], v6 offset:128
  s_waitcnt vmcnt(12)
  ds_read_b64_tr_b16 v[132:133], v6 offset:1024
  ds_read_b64_tr_b16 v[134:135], v6 offset:1152
  s_waitcnt vmcnt(11)
  ds_read_b64_tr_b16 v[136:137], v6 offset:2048
  ds_read_b64_tr_b16 v[138:139], v6 offset:2176
  s_waitcnt vmcnt(10)
  ds_read_b64_tr_b16 v[140:141], v6 offset:3072
  ds_read_b64_tr_b16 v[142:143], v6 offset:3200
  s_waitcnt vmcnt(9)
  ds_read_b64_tr_b16 v[144:145], v6 offset:4096
  ds_read_b64_tr_b16 v[146:147], v6 offset:4224
  s_waitcnt vmcnt(8)
  ds_read_b64_tr_b16 v[148:149], v6 offset:5120
  ds_read_b64_tr_b16 v[150:151], v6 offset:5248
  s_waitcnt vmcnt(7)
  ds_read_b64_tr_b16 v[152:153], v6 offset:6144
  ds_read_b64_tr_b16 v[154:155], v6 offset:6272
  s_waitcnt lgkmcnt(0)
  v_mfma_f32_16x16x32_bf16 v[32:35], v[128:131], v[64:67], 0
  v_mfma_f32_16x16x32_bf16 v[36:39], v[132:135], v[68:71], 0
  v_mfma_f32_16x16x32_bf16 v[32:35], v[136:139], v[72:75], v[32:35]
  v_mfma_f32_16x16x32_bf16 v[36:39], v[140:143], v[76:79], v[36:39]
  v_mfma_f32_16x16x32_bf16 v[32:35], v[144:147], v[80:83], v[32:35]
  v_mfma_f32_16x16x32_bf16 v[36:39], v[148:151], v[84:87], v[36:39]
  v_mfma_f32_16x16x32_bf16 v[32:35], v[152:155], v[88:91], v[32:35]
  s_waitcnt vmcnt(6)
  ds_read_b64_tr_b16 v[156:157], v6 offset:7168
  ds_read_b64_tr_b16 v[158:159], v6 offset:7296
  s_waitcnt vmcnt(5)
  ds_read_b64_tr_b16 v[160:161], v6 offset:8192
  ds_read_b64_tr_b16 v[162:163], v6 offset:8320
  s_waitcnt vmcnt(4)
  ds_read_b64_tr_b16 v[164:165], v6 offset:9216
  ds_read_b64_tr_b16 v[166:167], v6 offset:9344
  s_waitcnt vmcnt(3)
  ds_read_b64_tr_b16 v[168:169], v6 offset:10240
  ds_read_b64_tr_b16 v[170:171], v6 offset:10368
  s_waitcnt vmcnt(2)
  ds_read_b64_tr_b16 v[172:173], v6 offset:11264
  ds_read_b64_tr_b16 v[174:175], v6 offset:11392
  s_waitcnt vmcnt(1)
  ds_read_b64_tr_b16 v[176:177], v6 offset:12288
  ds_read_b64_tr_b16 v[178:179], v6 offset:12416
  s_waitcnt vmcnt(0)
  ds_read_b64_tr_b16 v[180:181], v6 offset:13312
  ds_read_b64_tr_b16 v[182:183], v6 offset:13440
  s_memrealtime s[70:71]
  s_waitcnt lgkmcnt(0)
  v_mfma_f32_16x16x32_bf16 v[36:39], v[156:159], v[92:95], v[36:39]
  v_mfma_f32_16x16x32_bf16 v[32:35], v[160:163], v[96:99], v[32:35]
  v_mfma_f32_16x16x32_bf16 v[36:39], v[164:167], v[100:103], v[36:39]
  v_mfma_f32_16x16x32_bf16 v[32:35], v[168:171], v[104:107], v[32:35]
  v_mfma_f32_16x16x32_bf16 v[36:39], v[172:175], v[108:111], v[36:39]
  v_mfma_f32_16x16x32_bf16 v[32:35], v[176:179], v[112:115], v[32:35]
  v_mfma_f32_16x16x32_bf16 v[36:39], v[180:183], v[116:119], v[36:39]
  s_xor_b32 s71, s70, 1540483477
  v_mov_b32 v9, s70
  v_mov_b32 v11, s71
  s_nop 4
  v_add_f32 v32, v32, v36
  v_add_f32 v33, v33, v37
  v_add_f32 v34, v34, v38
  v_add_f32 v35, v35, v39
  s_cmp_lg_u32 s29, 1
  s_cbranch_scc1 L_h_pst
  s_mov_b32 s35, 0xbfb8aa3b
  v_cvt_pk_bf16_f32 v32, v32, v32
  v_and_b32 v32, 0xffff0000, v32
  v_mul_f32 v16, s35, v32
  v_exp_f32 v16, v16
  s_nop 0
  v_add_f32 v16, 1.0, v16
  v_rcp_f32 v17, v16
  s_nop 0
  v_mul_f32 v18, v32, v17
  v_fma_f32 v19, -v18, v16, v32
  v_fma_f32 v19, v19, v17, v18
  v_cmp_class_f32 vcc, v19, 3
  s_nop 1
  v_cndmask_b32 v32, v19, v18, vcc
  v_cvt_pk_bf16_f32 v33, v33, v33
  v_and_b32 v33, 0xffff0000, v33
  v_mul_f32 v16, s35, v33
  v_exp_f32 v16, v16
  s_nop 0
  v_add_f32 v16, 1.0, v16
  v_rcp_f32 v17, v16
  s_nop 0
  v_mul_f32 v18, v33, v17
  v_fma_f32 v19, -v18, v16, v33
  v_fma_f32 v19, v19, v17, v18
  v_cmp_class_f32 vcc, v19, 3
  s_nop 1
  v_cndmask_b32 v33, v19, v18, vcc
  v_cvt_pk_bf16_f32 v34, v34, v34
  v_and_b32 v34, 0xffff0000, v34
  v_mul_f32 v16, s35, v34
  v_exp_f32 v16, v16
  s_nop 0
  v_add_f32 v16, 1.0, v16
  v_rcp_f32 v17, v16
  s_nop 0
  v_mul_f32 v18, v34, v17
  v_fma_f32 v19, -v18, v16, v34
  v_fma_f32 v19, v19, v17, v18
  v_cmp_class_f32 vcc, v19, 3
  s_nop 1
  v_cndmask_b32 v34, v19, v18, vcc
  v_cvt_pk_bf16_f32 v35, v35, v35
  v_and_b32 v35, 0xffff0000, v35
  v_mul_f32 v16, s35, v35
  v_exp_f32 v16, v16
  s_nop 0
  v_add_f32 v16, 1.0, v16
  v_rcp_f32 v17, v16
  s_nop 0
  v_mul_f32 v18, v35, v17
  v_fma_f32 v19, -v18, v16, v35
  v_fma_f32 v19, v19, v17, v18
  v_cmp_class_f32 vcc, v19, 3
  s_nop 1
  v_cndmask_b32 v35, v19, v18, vcc
L_h_pst:
  v_cvt_pk_bf16_f32 v8, v32, v33
  v_cvt_pk_bf16_f32 v10, v34, v35
  buffer_store_dwordx4 v[8:11], v7, s[52:55], s66 offen sc1
L_h_pdone:
  s_sub_u32 s72, s90, 1000
  s_mov_b32 s74, 7000
  s_mov_b32 s75, 1540483477
  s_cmp_eq_u32 s29, 1
  s_cbranch_scc1 L_h_ffn
  s_cmp_eq_u32 s29, 2
  s_cbranch_scc1 L_h_ffdone
  s_lshl_b32 s35, s27, 14
  s_lshl_b32 s36, s28, 10
  s_add_u32 s35, s35, s36
  s_add_u32 s35, s35, 1048576
  v_lshlrev_b32 v4, 4, v0
  s_mov_b32 s76, 40
L_h_qpoll:
  s_cmp_eq_u32 s76, 0
  s_cbranch_scc1 L_h_qfb
  s_sub_u32 s76, s76, 1
  s_sleep 16
  buffer_load_dwordx4 v[64:67], v4, s[52:55], s35 offen sc1
  s_waitcnt vmcnt(0)
  v_subrev_u32 v51, s72, v65
  v_xor_b32 v52, v65, v67
  v_cmp_le_u32 vcc, s74, v51
  v_xor_b32 v52, s75, v52
  s_nop 0
  v_cndmask_b32 v51, v61, v62, vcc
  v_or_b32 v50, v51, v52
  v_cmp_ne_u32 vcc, 0, v50
  s_nop 1
  s_cmp_lg_u64 vcc, 0
  s_cbranch_scc1 L_h_qpoll
  v_mov_b32 v65, v66
  v_lshlrev_b32 v5, 3, v0
  ds_write_b64 v5, v[64:65] offset:256
  s_branch L_h_qok
L_h_qfb:
  s_lshl_b32 s35, s28, 9
  s_add_u32 s48, s10, s35
  s_addc_u32 s49, s11, 0
  s_sub_u32 s50, 3670016, s35
  v_lshrrev_b32 v5, 5, v0
  v_lshlrev_b32 v4, 13, v5
  v_and_b32 v6, 31, v0
  v_lshl_add_u32 v4, v6, 4, v4
  s_mul_i32 s35, s27, 896
  v_lshlrev_b32 v5, 1, v5
  v_add_u32 v5, s35, v5
  s_mov_b32 s37, 0
  v_mov_b32 v8, 0
  v_mov_b32 v9, 0
  v_mov_b32 v10, 0
  v_mov_b32 v11, 0
  v_mov_b32 v12, 0
  v_mov_b32 v13, 0
  v_mov_b32 v14, 0
  v_mov_b32 v15, 0
L_h_qfl:
  buffer_load_dwordx4 v[64:67], v4, s[48:51], s37 offen nt
  s_add_u32 s37, s37, 16384
  ds_read_u16 v16, v5 offset:1024
  buffer_load_dwordx4 v[68:71], v4, s[48:51], s37 offen nt
  s_add_u32 s37, s37, 16384
  ds_read_u16 v18, v5 offset:1028
  buffer_load_dwordx4 v[72:75], v4, s[48:51], s37 offen nt
  s_add_u32 s37, s37, 16384
  ds_read_u16 v20, v5 offset:1032
  buffer_load_dwordx4 v[76:79], v4, s[48:51], s37 offen nt
  s_add_u32 s37, s37, 16384
  ds_read_u16 v22, v5 offset:1036
  s_waitcnt vmcnt(0) lgkmcnt(0)
  v_lshlrev_b32 v17, 16, v16
  v_dot2c_f32_bf16 v8, v16, v64
  v_dot2c_f32_bf16 v9, v17, v64
  v_dot2c_f32_bf16 v10, v16, v65
  v_dot2c_f32_bf16 v11, v17, v65
  v_dot2c_f32_bf16 v12, v16, v66
  v_dot2c_f32_bf16 v13, v17, v66
  v_dot2c_f32_bf16 v14, v16, v67
  v_dot2c_f32_bf16 v15, v17, v67
  v_lshlrev_b32 v19, 16, v18
  v_dot2c_f32_bf16 v8, v18, v68
  v_dot2c_f32_bf16 v9, v19, v68
  v_dot2c_f32_bf16 v10, v18, v69
  v_dot2c_f32_bf16 v11, v19, v69
  v_dot2c_f32_bf16 v12, v18, v70
  v_dot2c_f32_bf16 v13, v19, v70
  v_dot2c_f32_bf16 v14, v18, v71
  v_dot2c_f32_bf16 v15, v19, v71
  v_lshlrev_b32 v21, 16, v20
  v_dot2c_f32_bf16 v8, v20, v72
  v_dot2c_f32_bf16 v9, v21, v72
  v_dot2c_f32_bf16 v10, v20, v73
  v_dot2c_f32_bf16 v11, v21, v73
  v_dot2c_f32_bf16 v12, v20, v74
  v_dot2c_f32_bf16 v13, v21, v74
  v_dot2c_f32_bf16 v14, v20, v75
  v_dot2c_f32_bf16 v15, v21, v75
  v_lshlrev_b32 v23, 16, v22
  v_dot2c_f32_bf16 v8, v22, v76
  v_dot2c_f32_bf16 v9, v23, v76
  v_dot2c_f32_bf16 v10, v22, v77
  v_dot2c_f32_bf16 v11, v23, v77
  v_dot2c_f32_bf16 v12, v22, v78
  v_dot2c_f32_bf16 v13, v23, v78
  v_dot2c_f32_bf16 v14, v22, v79
  v_dot2c_f32_bf16 v15, v23, v79
  v_add_u32 v5, 16, v5
  s_cmp_lt_u32 s37, 3670016
  s_cbranch_scc1 L_h_qfl
  v_mov_b32 v16, v8
  s_nop 1
  v_permlane32_swap_b32 v8, v16
  v_add_f32 v8, v8, v16
  v_mov_b32 v17, v9
  s_nop 1
  v_permlane32_swap_b32 v9, v17
  v_add_f32 v9, v9, v17
  v_mov_b32 v18, v10
  s_nop 1
  v_permlane32_swap_b32 v10, v18
  v_add_f32 v10, v10, v18
  v_mov_b32 v19, v11
  s_nop 1
  v_permlane32_swap_b32 v11, v19
  v_add_f32 v11, v11, v19
  v_mov_b32 v20, v12
  s_nop 1
  v_permlane32_swap_b32 v12, v20
  v_add_f32 v12, v12, v20
  v_mov_b32 v21, v13
  s_nop 1
  v_permlane32_swap_b32 v13, v21
  v_add_f32 v13, v13, v21
  v_mov_b32 v22, v14
  s_nop 1
  v_permlane32_swap_b32 v14, v22
  v_add_f32 v14, v14, v22
  v_mov_b32 v23, v15
  s_nop 1
  v_permlane32_swap_b32 v15, v23
  v_add_f32 v15, v15, v23
  v_cvt_pk_bf16_f32 v8, v8, v9
  v_cvt_pk_bf16_f32 v9, v10, v11
  v_cvt_pk_bf16_f32 v10, v12, v13
  v_cvt_pk_bf16_f32 v11, v14, v15
  v_lshlrev_b32 v5, 4, v6
  ds_write_b128 v5, v[8:11] offset:256
L_h_qok:
  s_waitcnt lgkmcnt(0)
  s_mov_b64 exec, 1
  ds_add_u32 v61, v62 offset:4
  s_mov_b64 exec, -1
  s_branch L_h_ffdone
L_h_ffn:
L_h_ffdone:
  s_nop 1
L_poll_5:
  ds_read_b32 v3, v61 offset:4
  s_waitcnt lgkmcnt(0)
  v_readfirstlane_b32 s36, v3
  s_cmp_eq_u32 s36, 1
  s_cbranch_scc1 L_pd_6
  s_sleep 1
  s_branch L_poll_5
L_pd_6:
  s_mul_i32 s35, s28, 229376
  s_mul_i32 s36, s29, 224
  s_add_u32 s35, s35, s36
  s_add_u32 s48, s12, s35
  s_addc_u32 s49, s13, 0
  s_sub_u32 s50, 3670016, s35
  s_mov_b32 s51, 0x20000
  v_mul_u32_u24 v4, 4682, v0
  v_lshrrev_b32 v4, 16, v4
  v_mul_u32_u24 v5, 14, v4
  v_sub_u32 v5, v0, v5
  v_mul_u32_u24 v4, 896, v4
  v_lshl_add_u32 v4, v5, 4, v4
  v_cndmask_b32 v4, v2, v4, s[38:39]
  v_lshrrev_b32 v5, 4, v0
  v_lshlrev_b32 v5, 11, v5
  v_bfe_u32 v6, v0, 2, 2
  v_mul_u32_u24 v6, 224, v6
  v_add_u32 v5, v5, v6
  v_and_b32 v6, 3, v0
  v_lshl_add_u32 v5, v6, 3, v5
  v_add_u32 v5, s33, v5
  s_lshl_b32 s35, s29, 13
  v_lshlrev_b32 v6, 4, v0
  v_add_u32 v6, s35, v6
  v_add_u32 v6, 99328, v6
  s_add_u32 m0, s33, 0
  s_mov_b32 s37, 0
  buffer_load_dwordx4 v4, s[48:51], s37 offen nt lds
  s_add_u32 m0, s33, 1024
  s_mov_b32 s37, 3584
  buffer_load_dwordx4 v4, s[48:51], s37 offen nt lds
  s_waitcnt vmcnt(1)
  s_add_u32 m0, s33, 2048
  s_mov_b32 s37, 7168
  buffer_load_dwordx4 v4, s[48:51], s37 offen nt lds
  s_waitcnt vmcnt(1)
  s_add_u32 m0, s33, 3072
  s_mov_b32 s37, 10752
  buffer_load_dwordx4 v4, s[48:51], s37 offen nt lds
  s_waitcnt vmcnt(1)
  s_add_u32 m0, s33, 4096
  s_mov_b32 s37, 14336
  buffer_load_dwordx4 v4, s[48:51], s37 offen nt lds
  s_waitcnt vmcnt(1)
  s_add_u32 m0, s33, 5120
  s_mov_b32 s37, 17920
  buffer_load_dwordx4 v4, s[48:51], s37 offen nt lds
  s_waitcnt vmcnt(1)
  s_add_u32 m0, s33, 6144
  s_mov_b32 s37, 21504
  buffer_load_dwordx4 v4, s[48:51], s37 offen nt lds
  s_waitcnt vmcnt(1)
  s_add_u32 m0, s33, 7168
  s_mov_b32 s37, 25088
  buffer_load_dwordx4 v4, s[48:51], s37 offen nt lds
  s_waitcnt vmcnt(1)
  s_add_u32 m0, s33, 8192
  s_mov_b32 s37, 28672
  buffer_load_dwordx4 v4, s[48:51], s37 offen nt lds
  s_waitcnt vmcnt(1)
  ds_read_b64_tr_b16 v[64:65], v5 offset:0
  ds_read_b64_tr_b16 v[66:67], v5 offset:1024
  ds_read_b64_tr_b16 v[96:97], v5 offset:32
  ds_read_b64_tr_b16 v[98:99], v5 offset:1056
  ds_read_b64_tr_b16 v[128:129], v5 offset:64
  ds_read_b64_tr_b16 v[130:131], v5 offset:1088
  ds_read_b64_tr_b16 v[160:161], v5 offset:96
  ds_read_b64_tr_b16 v[162:163], v5 offset:1120
  ds_read_b64_tr_b16 v[192:193], v5 offset:128
  ds_read_b64_tr_b16 v[194:195], v5 offset:1152
  ds_read_b64_tr_b16 v[224:225], v5 offset:160
  ds_read_b64_tr_b16 v[226:227], v5 offset:1184
  ds_read_b64_tr_b16 v[8:9], v5 offset:192
  ds_read_b64_tr_b16 v[10:11], v5 offset:1216
  s_waitcnt lgkmcnt(0)
  ds_write_b128 v6, v[8:11] offset:0
  s_waitcnt vmcnt(1)
  s_add_u32 m0, s33, 9216
  s_mov_b32 s37, 32256
  buffer_load_dwordx4 v4, s[48:51], s37 offen nt lds
  s_waitcnt vmcnt(1)
  s_add_u32 m0, s33, 10240
  s_mov_b32 s37, 35840
  buffer_load_dwordx4 v4, s[48:51], s37 offen nt lds
  s_waitcnt vmcnt(1)
  s_add_u32 m0, s33, 11264
  s_mov_b32 s37, 39424
  buffer_load_dwordx4 v4, s[48:51], s37 offen nt lds
  s_waitcnt vmcnt(1)
  s_add_u32 m0, s33, 12288
  s_mov_b32 s37, 43008
  buffer_load_dwordx4 v4, s[48:51], s37 offen nt lds
  s_waitcnt vmcnt(1)
  s_add_u32 m0, s33, 13312
  s_mov_b32 s37, 46592
  buffer_load_dwordx4 v4, s[48:51], s37 offen nt lds
  s_waitcnt vmcnt(1)
  s_add_u32 m0, s33, 14336
  s_mov_b32 s37, 50176
  buffer_load_dwordx4 v4, s[48:51], s37 offen nt lds
  s_waitcnt vmcnt(1)
  s_add_u32 m0, s33, 15360
  s_mov_b32 s37, 53760
  buffer_load_dwordx4 v4, s[48:51], s37 offen nt lds
  s_waitcnt vmcnt(1)
  s_add_u32 m0, s33, 0
  s_mov_b32 s37, 57344
  buffer_load_dwordx4 v4, s[48:51], s37 offen nt lds
  s_waitcnt vmcnt(1)
  ds_read_b64_tr_b16 v[68:69], v5 offset:8192
  ds_read_b64_tr_b16 v[70:71], v5 offset:9216
  ds_read_b64_tr_b16 v[100:101], v5 offset:8224
  ds_read_b64_tr_b16 v[102:103], v5 offset:9248
  ds_read_b64_tr_b16 v[132:133], v5 offset:8256
  ds_read_b64_tr_b16 v[134:135], v5 offset:9280
  ds_read_b64_tr_b16 v[164:165], v5 offset:8288
  ds_read_b64_tr_b16 v[166:167], v5 offset:9312
  ds_read_b64_tr_b16 v[196:197], v5 offset:8320
  ds_read_b64_tr_b16 v[198:199], v5 offset:9344
  ds_read_b64_tr_b16 v[228:229], v5 offset:8352
  ds_read_b64_tr_b16 v[230:231], v5 offset:9376
  ds_read_b64_tr_b16 v[8:9], v5 offset:8384
  ds_read_b64_tr_b16 v[10:11], v5 offset:9408
  s_waitcnt lgkmcnt(0)
  ds_write_b128 v6, v[8:11] offset:1024
  s_waitcnt vmcnt(1)
  s_add_u32 m0, s33, 1024
  s_mov_b32 s37, 60928
  buffer_load_dwordx4 v4, s[48:51], s37 offen nt lds
  s_waitcnt vmcnt(1)
  s_add_u32 m0, s33, 2048
  s_mov_b32 s37, 64512
  buffer_load_dwordx4 v4, s[48:51], s37 offen nt lds
  s_waitcnt vmcnt(1)
  s_add_u32 m0, s33, 3072
  s_mov_b32 s37, 68096
  buffer_load_dwordx4 v4, s[48:51], s37 offen nt lds
  s_waitcnt vmcnt(1)
  s_add_u32 m0, s33, 4096
  s_mov_b32 s37, 71680
  buffer_load_dwordx4 v4, s[48:51], s37 offen nt lds
  s_waitcnt vmcnt(1)
  s_add_u32 m0, s33, 5120
  s_mov_b32 s37, 75264
  buffer_load_dwordx4 v4, s[48:51], s37 offen nt lds
  s_waitcnt vmcnt(1)
  s_add_u32 m0, s33, 6144
  s_mov_b32 s37, 78848
  buffer_load_dwordx4 v4, s[48:51], s37 offen nt lds
  s_waitcnt vmcnt(1)
  s_add_u32 m0, s33, 7168
  s_mov_b32 s37, 82432
  buffer_load_dwordx4 v4, s[48:51], s37 offen nt lds
  s_waitcnt vmcnt(1)
  s_add_u32 m0, s33, 8192
  s_mov_b32 s37, 86016
  buffer_load_dwordx4 v4, s[48:51], s37 offen nt lds
  s_waitcnt vmcnt(1)
  ds_read_b64_tr_b16 v[72:73], v5 offset:0
  ds_read_b64_tr_b16 v[74:75], v5 offset:1024
  ds_read_b64_tr_b16 v[104:105], v5 offset:32
  ds_read_b64_tr_b16 v[106:107], v5 offset:1056
  ds_read_b64_tr_b16 v[136:137], v5 offset:64
  ds_read_b64_tr_b16 v[138:139], v5 offset:1088
  ds_read_b64_tr_b16 v[168:169], v5 offset:96
  ds_read_b64_tr_b16 v[170:171], v5 offset:1120
  ds_read_b64_tr_b16 v[200:201], v5 offset:128
  ds_read_b64_tr_b16 v[202:203], v5 offset:1152
  ds_read_b64_tr_b16 v[232:233], v5 offset:160
  ds_read_b64_tr_b16 v[234:235], v5 offset:1184
  ds_read_b64_tr_b16 v[8:9], v5 offset:192
  ds_read_b64_tr_b16 v[10:11], v5 offset:1216
  s_waitcnt lgkmcnt(0)
  ds_write_b128 v6, v[8:11] offset:2048
  s_waitcnt vmcnt(1)
  s_add_u32 m0, s33, 9216
  s_mov_b32 s37, 89600
  buffer_load_dwordx4 v4, s[48:51], s37 offen nt lds
  s_waitcnt vmcnt(1)
  s_add_u32 m0, s33, 10240
  s_mov_b32 s37, 93184
  buffer_load_dwordx4 v4, s[48:51], s37 offen nt lds
  s_waitcnt vmcnt(1)
  s_add_u32 m0, s33, 11264
  s_mov_b32 s37, 96768
  buffer_load_dwordx4 v4, s[48:51], s37 offen nt lds
  s_waitcnt vmcnt(1)
  s_add_u32 m0, s33, 12288
  s_mov_b32 s37, 100352
  buffer_load_dwordx4 v4, s[48:51], s37 offen nt lds
  s_waitcnt vmcnt(1)
  s_add_u32 m0, s33, 13312
  s_mov_b32 s37, 103936
  buffer_load_dwordx4 v4, s[48:51], s37 offen nt lds
  s_waitcnt vmcnt(1)
  s_add_u32 m0, s33, 14336
  s_mov_b32 s37, 107520
  buffer_load_dwordx4 v4, s[48:51], s37 offen nt lds
  s_waitcnt vmcnt(1)
  s_add_u32 m0, s33, 15360
  s_mov_b32 s37, 111104
  buffer_load_dwordx4 v4, s[48:51], s37 offen nt lds
  s_waitcnt vmcnt(1)
  s_add_u32 m0, s33, 0
  s_mov_b32 s37, 114688
  buffer_load_dwordx4 v4, s[48:51], s37 offen nt lds
  s_waitcnt vmcnt(1)
  ds_read_b64_tr_b16 v[76:77], v5 offset:8192
  ds_read_b64_tr_b16 v[78:79], v5 offset:9216
  ds_read_b64_tr_b16 v[108:109], v5 offset:8224
  ds_read_b64_tr_b16 v[110:111], v5 offset:9248
  ds_read_b64_tr_b16 v[140:141], v5 offset:8256
  ds_read_b64_tr_b16 v[142:143], v5 offset:9280
  ds_read_b64_tr_b16 v[172:173], v5 offset:8288
  ds_read_b64_tr_b16 v[174:175], v5 offset:9312
  ds_read_b64_tr_b16 v[204:205], v5 offset:8320
  ds_read_b64_tr_b16 v[206:207], v5 offset:9344
  ds_read_b64_tr_b16 v[236:237], v5 offset:8352
  ds_read_b64_tr_b16 v[238:239], v5 offset:9376
  ds_read_b64_tr_b16 v[8:9], v5 offset:8384
  ds_read_b64_tr_b16 v[10:11], v5 offset:9408
  s_waitcnt lgkmcnt(0)
  ds_write_b128 v6, v[8:11] offset:3072
  s_waitcnt vmcnt(1)
  s_add_u32 m0, s33, 1024
  s_mov_b32 s37, 118272
  buffer_load_dwordx4 v4, s[48:51], s37 offen nt lds
  s_waitcnt vmcnt(1)
  s_add_u32 m0, s33, 2048
  s_mov_b32 s37, 121856
  buffer_load_dwordx4 v4, s[48:51], s37 offen nt lds
  s_waitcnt vmcnt(1)
  s_add_u32 m0, s33, 3072
  s_mov_b32 s37, 125440
  buffer_load_dwordx4 v4, s[48:51], s37 offen nt lds
  s_waitcnt vmcnt(1)
  s_add_u32 m0, s33, 4096
  s_mov_b32 s37, 129024
  buffer_load_dwordx4 v4, s[48:51], s37 offen nt lds
  s_waitcnt vmcnt(1)
  s_add_u32 m0, s33, 5120
  s_mov_b32 s37, 132608
  buffer_load_dwordx4 v4, s[48:51], s37 offen nt lds
  s_waitcnt vmcnt(1)
  s_add_u32 m0, s33, 6144
  s_mov_b32 s37, 136192
  buffer_load_dwordx4 v4, s[48:51], s37 offen nt lds
  s_waitcnt vmcnt(1)
  s_add_u32 m0, s33, 7168
  s_mov_b32 s37, 139776
  buffer_load_dwordx4 v4, s[48:51], s37 offen nt lds
  s_waitcnt vmcnt(1)
  s_add_u32 m0, s33, 8192
  s_mov_b32 s37, 143360
  buffer_load_dwordx4 v4, s[48:51], s37 offen nt lds
  s_waitcnt vmcnt(1)
  ds_read_b64_tr_b16 v[80:81], v5 offset:0
  ds_read_b64_tr_b16 v[82:83], v5 offset:1024
  ds_read_b64_tr_b16 v[112:113], v5 offset:32
  ds_read_b64_tr_b16 v[114:115], v5 offset:1056
  ds_read_b64_tr_b16 v[144:145], v5 offset:64
  ds_read_b64_tr_b16 v[146:147], v5 offset:1088
  ds_read_b64_tr_b16 v[176:177], v5 offset:96
  ds_read_b64_tr_b16 v[178:179], v5 offset:1120
  ds_read_b64_tr_b16 v[208:209], v5 offset:128
  ds_read_b64_tr_b16 v[210:211], v5 offset:1152
  ds_read_b64_tr_b16 v[240:241], v5 offset:160
  ds_read_b64_tr_b16 v[242:243], v5 offset:1184
  ds_read_b64_tr_b16 v[8:9], v5 offset:192
  ds_read_b64_tr_b16 v[10:11], v5 offset:1216
  s_waitcnt lgkmcnt(0)
  ds_write_b128 v6, v[8:11] offset:4096
  s_waitcnt vmcnt(1)
  s_add_u32 m0, s33, 9216
  s_mov_b32 s37, 146944
  buffer_load_dwordx4 v4, s[48:51], s37 offen nt lds
  s_waitcnt vmcnt(1)
  s_add_u32 m0, s33, 10240
  s_mov_b32 s37, 150528
  buffer_load_dwordx4 v4, s[48:51], s37 offen nt lds
  s_waitcnt vmcnt(1)
  s_add_u32 m0, s33, 11264
  s_mov_b32 s37, 154112
  buffer_load_dwordx4 v4, s[48:51], s37 offen nt lds
  s_waitcnt vmcnt(1)
  s_add_u32 m0, s33, 12288
  s_mov_b32 s37, 157696
  buffer_load_dwordx4 v4, s[48:51], s37 offen nt lds
  s_waitcnt vmcnt(1)
  s_add_u32 m0, s33, 13312
  s_mov_b32 s37, 161280
  buffer_load_dwordx4 v4, s[48:51], s37 offen nt lds
  s_waitcnt vmcnt(1)
  s_add_u32 m0, s33, 14336
  s_mov_b32 s37, 164864
  buffer_load_dwordx4 v4, s[48:51], s37 offen nt lds
  s_waitcnt vmcnt(1)
  s_add_u32 m0, s33, 15360
  s_mov_b32 s37, 168448
  buffer_load_dwordx4 v4, s[48:51], s37 offen nt lds
  s_waitcnt vmcnt(1)
  s_add_u32 m0, s33, 0
  s_mov_b32 s37, 172032
  buffer_load_dwordx4 v4, s[48:51], s37 offen nt lds
  s_waitcnt vmcnt(1)
  ds_read_b64_tr_b16 v[84:85], v5 offset:8192
  ds_read_b64_tr_b16 v[86:87], v5 offset:9216
  ds_read_b64_tr_b16 v[116:117], v5 offset:8224
  ds_read_b64_tr_b16 v[118:119], v5 offset:9248
  ds_read_b64_tr_b16 v[148:149], v5 offset:8256
  ds_read_b64_tr_b16 v[150:151], v5 offset:9280
  ds_read_b64_tr_b16 v[180:181], v5 offset:8288
  ds_read_b64_tr_b16 v[182:183], v5 offset:9312
  ds_read_b64_tr_b16 v[212:213], v5 offset:8320
  ds_read_b64_tr_b16 v[214:215], v5 offset:9344
  ds_read_b64_tr_b16 v[244:245], v5 offset:8352
  ds_read_b64_tr_b16 v[246:247], v5 offset:9376
  ds_read_b64_tr_b16 v[8:9], v5 offset:8384
  ds_read_b64_tr_b16 v[10:11], v5 offset:9408
  s_waitcnt lgkmcnt(0)
  ds_write_b128 v6, v[8:11] offset:5120
  s_waitcnt vmcnt(1)
  s_add_u32 m0, s33, 1024
  s_mov_b32 s37, 175616
  buffer_load_dwordx4 v4, s[48:51], s37 offen nt lds
  s_waitcnt vmcnt(1)
  s_add_u32 m0, s33, 2048
  s_mov_b32 s37, 179200
  buffer_load_dwordx4 v4, s[48:51], s37 offen nt lds
  s_waitcnt vmcnt(1)
  s_add_u32 m0, s33, 3072
  s_mov_b32 s37, 182784
  buffer_load_dwordx4 v4, s[48:51], s37 offen nt lds
  s_waitcnt vmcnt(1)
  s_add_u32 m0, s33, 4096
  s_mov_b32 s37, 186368
  buffer_load_dwordx4 v4, s[48:51], s37 offen nt lds
  s_waitcnt vmcnt(1)
  s_add_u32 m0, s33, 5120
  s_mov_b32 s37, 189952
  buffer_load_dwordx4 v4, s[48:51], s37 offen nt lds
  s_waitcnt vmcnt(1)
  s_add_u32 m0, s33, 6144
  s_mov_b32 s37, 193536
  buffer_load_dwordx4 v4, s[48:51], s37 offen nt lds
  s_waitcnt vmcnt(1)
  s_add_u32 m0, s33, 7168
  s_mov_b32 s37, 197120
  buffer_load_dwordx4 v4, s[48:51], s37 offen nt lds
  s_waitcnt vmcnt(1)
  s_add_u32 m0, s33, 8192
  s_mov_b32 s37, 200704
  buffer_load_dwordx4 v4, s[48:51], s37 offen nt lds
  s_waitcnt vmcnt(1)
  ds_read_b64_tr_b16 v[88:89], v5 offset:0
  ds_read_b64_tr_b16 v[90:91], v5 offset:1024
  ds_read_b64_tr_b16 v[120:121], v5 offset:32
  ds_read_b64_tr_b16 v[122:123], v5 offset:1056
  ds_read_b64_tr_b16 v[152:153], v5 offset:64
  ds_read_b64_tr_b16 v[154:155], v5 offset:1088
  ds_read_b64_tr_b16 v[184:185], v5 offset:96
  ds_read_b64_tr_b16 v[186:187], v5 offset:1120
  ds_read_b64_tr_b16 v[216:217], v5 offset:128
  ds_read_b64_tr_b16 v[218:219], v5 offset:1152
  ds_read_b64_tr_b16 v[248:249], v5 offset:160
  ds_read_b64_tr_b16 v[250:251], v5 offset:1184
  ds_read_b64_tr_b16 v[8:9], v5 offset:192
  ds_read_b64_tr_b16 v[10:11], v5 offset:1216
  s_waitcnt lgkmcnt(0)
  ds_write_b128 v6, v[8:11] offset:6144
  s_waitcnt vmcnt(1)
  s_add_u32 m0, s33, 9216
  s_mov_b32 s37, 204288
  buffer_load_dwordx4 v4, s[48:51], s37 offen nt lds
  s_waitcnt vmcnt(1)
  s_add_u32 m0, s33, 10240
  s_mov_b32 s37, 207872
  buffer_load_dwordx4 v4, s[48:51], s37 offen nt lds
  s_waitcnt vmcnt(1)
  s_add_u32 m0, s33, 11264
  s_mov_b32 s37, 211456
  buffer_load_dwordx4 v4, s[48:51], s37 offen nt lds
  s_waitcnt vmcnt(1)
  s_add_u32 m0, s33, 12288
  s_mov_b32 s37, 215040
  buffer_load_dwordx4 v4, s[48:51], s37 offen nt lds
  s_waitcnt vmcnt(1)
  s_add_u32 m0, s33, 13312
  s_mov_b32 s37, 218624
  buffer_load_dwordx4 v4, s[48:51], s37 offen nt lds
  s_waitcnt vmcnt(1)
  s_add_u32 m0, s33, 14336
  s_mov_b32 s37, 222208
  buffer_load_dwordx4 v4, s[48:51], s37 offen nt lds
  s_waitcnt vmcnt(1)
  s_add_u32 m0, s33, 15360
  s_mov_b32 s37, 225792
  buffer_load_dwordx4 v4, s[48:51], s37 offen nt lds
  s_waitcnt vmcnt(0)
  ds_read_b64_tr_b16 v[92:93], v5 offset:8192
  ds_read_b64_tr_b16 v[94:95], v5 offset:9216
  ds_read_b64_tr_b16 v[124:125], v5 offset:8224
  ds_read_b64_tr_b16 v[126:127], v5 offset:9248
  ds_read_b64_tr_b16 v[156:157], v5 offset:8256
  ds_read_b64_tr_b16 v[158:159], v5 offset:9280
  ds_read_b64_tr_b16 v[188:189], v5 offset:8288
  ds_read_b64_tr_b16 v[190:191], v5 offset:9312
  ds_read_b64_tr_b16 v[220:221], v5 offset:8320
  ds_read_b64_tr_b16 v[222:223], v5 offset:9344
  ds_read_b64_tr_b16 v[252:253], v5 offset:8352
  ds_read_b64_tr_b16 v[254:255], v5 offset:9376
  ds_read_b64_tr_b16 v[8:9], v5 offset:8384
  ds_read_b64_tr_b16 v[10:11], v5 offset:9408
  s_waitcnt lgkmcnt(0)
  ds_write_b128 v6, v[8:11] offset:7168
  s_cmp_lg_u32 s29, 1
  s_cbranch_scc1 L_h_f2done
  s_xor_b32 s78, s2, 255
  s_cmp_ge_u32 s78, 98
  s_cbranch_scc1 L_h_f2done
  s_mul_i32 s68, s78, 9363
  s_lshr_b32 s68, s68, 16
  s_mul_i32 s35, s68, 7
  s_sub_u32 s78, s78, s35
  s_mul_i32 s35, s68, 114688
  s_lshl_b32 s36, s78, 7
  s_add_u32 s35, s35, s36
  s_add_u32 s48, s18, s35
  s_addc_u32 s49, s19, 0
  s_sub_u32 s50, 1605632, s35
  v_lshrrev_b32 v4, 3, v0
  v_mul_u32_u24 v4, 896, v4
  v_and_b32 v3, 7, v0
  v_lshl_add_u32 v4, v3, 4, v4
  s_add_u32 m0, s33, 0
  s_mov_b32 s37, 0
  buffer_load_dwordx4 v4, s[48:51], s37 offen nt lds
  s_add_u32 m0, s33, 1024
  s_mov_b32 s37, 7168
  buffer_load_dwordx4 v4, s[48:51], s37 offen nt lds
  s_add_u32 m0, s33, 2048
  s_mov_b32 s37, 14336
  buffer_load_dwordx4 v4, s[48:51], s37 offen nt lds
  s_add_u32 m0, s33, 3072
  s_mov_b32 s37, 21504
  buffer_load_dwordx4 v4, s[48:51], s37 offen nt lds
  s_waitcnt vmcnt(3)
  s_add_u32 m0, s33, 4096
  s_mov_b32 s37, 28672
  buffer_load_dwordx4 v4, s[48:51], s37 offen nt lds
  s_waitcnt vmcnt(3)
  s_add_u32 m0, s33, 5120
  s_mov_b32 s37, 35840
  buffer_load_dwordx4 v4, s[48:51], s37 offen nt lds
  s_waitcnt vmcnt(3)
  s_add_u32 m0, s33, 6144
  s_mov_b32 s37, 43008
  buffer_load_dwordx4 v4, s[48:51], s37 offen nt lds
  s_waitcnt vmcnt(3)
  s_add_u32 m0, s33, 7168
  s_mov_b32 s37, 50176
  buffer_load_dwordx4 v4, s[48:51], s37 offen nt lds
  s_waitcnt vmcnt(3)
  s_add_u32 m0, s33, 8192
  s_mov_b32 s37, 57344
  buffer_load_dwordx4 v4, s[48:51], s37 offen nt lds
  s_waitcnt vmcnt(3)
  s_add_u32 m0, s33, 9216
  s_mov_b32 s37, 64512
  buffer_load_dwordx4 v4, s[48:51], s37 offen nt lds
  s_waitcnt vmcnt(3)
  s_add_u32 m0, s33, 10240
  s_mov_b32 s37, 71680
  buffer_load_dwordx4 v4, s[48:51], s37 offen nt lds
  s_waitcnt vmcnt(3)
  s_add_u32 m0, s33, 11264
  s_mov_b32 s37, 78848
  buffer_load_dwordx4 v4, s[48:51], s37 offen nt lds
  s_waitcnt vmcnt(3)
  s_add_u32 m0, s33, 12288
  s_mov_b32 s37, 86016
  buffer_load_dwordx4 v4, s[48:51], s37 offen nt lds
  s_waitcnt vmcnt(3)
  s_add_u32 m0, s33, 13312
  s_mov_b32 s37, 93184
  buffer_load_dwordx4 v4, s[48:51], s37 offen nt lds
  s_waitcnt vmcnt(3)
  s_add_u32 m0, s33, 14336
  s_mov_b32 s37, 100352
  buffer_load_dwordx4 v4, s[48:51], s37 offen nt lds
  s_waitcnt vmcnt(3)
  s_add_u32 m0, s33, 15360
  s_mov_b32 s37, 107520
  buffer_load_dwordx4 v4, s[48:51], s37 offen nt lds
  v_lshlrev_b32 v4, 4, v0
  v_lshrrev_b32 v7, 4, v0
  v_lshlrev_b32 v7, 8, v7
  v_and_b32 v3, 15, v0
  v_lshl_add_u32 v7, v3, 3, v7
  s_lshl_b32 s35, s68, 12
  s_add_u32 s35, s35, 2097152
  s_mov_b32 s76, 40
L_h_hpoll:
  s_cmp_eq_u32 s76, 0
  s_cbranch_scc1 L_h_hfb
  s_sub_u32 s76, s76, 1
  buffer_load_dwordx4 v[28:31], v4, s[52:55], s35 offen offset:0 sc1
  buffer_load_dwordx4 v[32:35], v4, s[52:55], s35 offen offset:1024 sc1
  buffer_load_dwordx4 v[36:39], v4, s[52:55], s35 offen offset:2048 sc1
  buffer_load_dwordx4 v[40:43], v4, s[52:55], s35 offen offset:3072 sc1
  s_waitcnt vmcnt(3)
  v_subrev_u32 v25, s72, v29
  v_xor_b32 v26, v29, v31
  v_cmp_le_u32 vcc, s74, v25
  v_xor_b32 v26, s75, v26
  s_nop 0
  v_cndmask_b32 v25, v61, v62, vcc
  v_or_b32 v24, v25, v26
  s_waitcnt vmcnt(2)
  v_subrev_u32 v25, s72, v33
  v_xor_b32 v26, v33, v35
  v_cmp_le_u32 vcc, s74, v25
  v_xor_b32 v26, s75, v26
  s_nop 0
  v_cndmask_b32 v25, v61, v62, vcc
  v_or3_b32 v24, v24, v25, v26
  s_waitcnt vmcnt(1)
  v_subrev_u32 v25, s72, v37
  v_xor_b32 v26, v37, v39
  v_cmp_le_u32 vcc, s74, v25
  v_xor_b32 v26, s75, v26
  s_nop 0
  v_cndmask_b32 v25, v61, v62, vcc
  v_or3_b32 v24, v24, v25, v26
  s_waitcnt vmcnt(0)
  v_subrev_u32 v25, s72, v41
  v_xor_b32 v26, v41, v43
  v_cmp_le_u32 vcc, s74, v25
  v_xor_b32 v26, s75, v26
  s_nop 0
  v_cndmask_b32 v25, v61, v62, vcc
  v_or3_b32 v24, v24, v25, v26
  v_cmp_ne_u32 vcc, 0, v24
  s_nop 1
  s_cmp_eq_u64 vcc, 0
  s_cbranch_scc1 L_h_hgot
  s_sleep 8
  s_branch L_h_hpoll
L_h_hgot:
  v_mov_b32 v29, v30
  ds_write_b64 v7, v[28:29] offset:30720
  v_mov_b32 v33, v34
  ds_write_b64 v7, v[32:33] offset:31744
  v_mov_b32 v37, v38
  ds_write_b64 v7, v[36:37] offset:30848
  v_mov_b32 v41, v42
  ds_write_b64 v7, v[40:41] offset:31872
  s_branch L_h_hok
L_h_hfb:
  s_waitcnt vmcnt(0)
  s_lshl_b32 s35, s68, 8
  s_add_u32 s48, s16, s35
  s_addc_u32 s49, s17, 0
  s_sub_u32 s50, 1605632, s35
  v_lshrrev_b32 v7, 4, v0
  v_mul_u32_u24 v4, 3584, v7
  v_and_b32 v3, 15, v0
  v_lshl_add_u32 v4, v3, 4, v4
  v_lshlrev_b32 v3, 4, v3
  v_lshlrev_b32 v7, 1, v7
  s_mov_b32 s76, 0
L_h_hfb2:
  s_mov_b32 s37, 0
  v_mov_b32 v8, 0
  v_mov_b32 v9, 0
  v_mov_b32 v10, 0
  v_mov_b32 v11, 0
  v_mov_b32 v12, 0
  v_mov_b32 v13, 0
  v_mov_b32 v14, 0
  v_mov_b32 v15, 0
L_h_hfl:
  buffer_load_dwordx4 v[44:47], v4, s[48:51], s37 offen nt
  ds_read_u16 v16, v7 offset:1024
  s_add_u32 s37, s37, 14336
  v_add_u32 v7, 8, v7
  s_waitcnt vmcnt(0) lgkmcnt(0)
  v_lshlrev_b32 v17, 16, v16
  v_dot2c_f32_bf16 v8, v16, v44
  v_dot2c_f32_bf16 v9, v17, v44
  v_dot2c_f32_bf16 v10, v16, v45
  v_dot2c_f32_bf16 v11, v17, v45
  v_dot2c_f32_bf16 v12, v16, v46
  v_dot2c_f32_bf16 v13, v17, v46
  v_dot2c_f32_bf16 v14, v16, v47
  v_dot2c_f32_bf16 v15, v17, v47
  s_cmp_lt_u32 s37, 1605632
  s_cbranch_scc1 L_h_hfl
  v_mov_b32 v16, v8
  s_nop 1
  v_permlane16_swap_b32 v8, v16
  v_add_f32 v8, v8, v16
  v_mov_b32 v17, v9
  s_nop 1
  v_permlane16_swap_b32 v9, v17
  v_add_f32 v9, v9, v17
  v_mov_b32 v18, v10
  s_nop 1
  v_permlane16_swap_b32 v10, v18
  v_add_f32 v10, v10, v18
  v_mov_b32 v19, v11
  s_nop 1
  v_permlane16_swap_b32 v11, v19
  v_add_f32 v11, v11, v19
  v_mov_b32 v20, v12
  s_nop 1
  v_permlane16_swap_b32 v12, v20
  v_add_f32 v12, v12, v20
  v_mov_b32 v21, v13
  s_nop 1
  v_permlane16_swap_b32 v13, v21
  v_add_f32 v13, v13, v21
  v_mov_b32 v22, v14
  s_nop 1
  v_permlane16_swap_b32 v14, v22
  v_add_f32 v14, v14, v22
  v_mov_b32 v23, v15
  s_nop 1
  v_permlane16_swap_b32 v15, v23
  v_add_f32 v15, v15, v23
  v_mov_b32 v16, v8
  s_nop 1
  v_permlane32_swap_b32 v8, v16
  v_add_f32 v8, v8, v16
  v_mov_b32 v17, v9
  s_nop 1
  v_permlane32_swap_b32 v9, v17
  v_add_f32 v9, v9, v17
  v_mov_b32 v18, v10
  s_nop 1
  v_permlane32_swap_b32 v10, v18
  v_add_f32 v10, v10, v18
  v_mov_b32 v19, v11
  s_nop 1
  v_permlane32_swap_b32 v11, v19
  v_add_f32 v11, v11, v19
  v_mov_b32 v20, v12
  s_nop 1
  v_permlane32_swap_b32 v12, v20
  v_add_f32 v12, v12, v20
  v_mov_b32 v21, v13
  s_nop 1
  v_permlane32_swap_b32 v13, v21
  v_add_f32 v13, v13, v21
  v_mov_b32 v22, v14
  s_nop 1
  v_permlane32_swap_b32 v14, v22
  v_add_f32 v14, v14, v22
  v_mov_b32 v23, v15
  s_nop 1
  v_permlane32_swap_b32 v15, v23
  v_add_f32 v15, v15, v23
  s_mov_b32 s35, 0xbfb8aa3b
  v_cvt_pk_bf16_f32 v8, v8, v8
  v_and_b32 v8, 0xffff0000, v8
  v_mul_f32 v16, s35, v8
  v_exp_f32 v16, v16
  s_nop 0
  v_add_f32 v16, 1.0, v16
  v_rcp_f32 v17, v16
  s_nop 0
  v_mul_f32 v18, v8, v17
  v_fma_f32 v19, -v18, v16, v8
  v_fma_f32 v19, v19, v17, v18
  v_cmp_class_f32 vcc, v19, 3
  s_nop 1
  v_cndmask_b32 v8, v19, v18, vcc
  v_cvt_pk_bf16_f32 v9, v9, v9
  v_and_b32 v9, 0xffff0000, v9
  v_mul_f32 v16, s35, v9
  v_exp_f32 v16, v16
  s_nop 0
  v_add_f32 v16, 1.0, v16
  v_rcp_f32 v17, v16
  s_nop 0
  v_mul_f32 v18, v9, v17
  v_fma_f32 v19, -v18, v16, v9
  v_fma_f32 v19, v19, v17, v18
  v_cmp_class_f32 vcc, v19, 3
  s_nop 1
  v_cndmask_b32 v9, v19, v18, vcc
  v_cvt_pk_bf16_f32 v10, v10, v10
  v_and_b32 v10, 0xffff0000, v10
  v_mul_f32 v16, s35, v10
  v_exp_f32 v16, v16
  s_nop 0
  v_add_f32 v16, 1.0, v16
  v_rcp_f32 v17, v16
  s_nop 0
  v_mul_f32 v18, v10, v17
  v_fma_f32 v19, -v18, v16, v10
  v_fma_f32 v19, v19, v17, v18
  v_cmp_class_f32 vcc, v19, 3
  s_nop 1
  v_cndmask_b32 v10, v19, v18, vcc
  v_cvt_pk_bf16_f32 v11, v11, v11
  v_and_b32 v11, 0xffff0000, v11
  v_mul_f32 v16, s35, v11
  v_exp_f32 v16, v16
  s_nop 0
  v_add_f32 v16, 1.0, v16
  v_rcp_f32 v17, v16
  s_nop 0
  v_mul_f32 v18, v11, v17
  v_fma_f32 v19, -v18, v16, v11
  v_fma_f32 v19, v19, v17, v18
  v_cmp_class_f32 vcc, v19, 3
  s_nop 1
  v_cndmask_b32 v11, v19, v18, vcc
  v_cvt_pk_bf16_f32 v12, v12, v12
  v_and_b32 v12, 0xffff0000, v12
  v_mul_f32 v16, s35, v12
  v_exp_f32 v16, v16
  s_nop 0
  v_add_f32 v16, 1.0, v16
  v_rcp_f32 v17, v16
  s_nop 0
  v_mul_f32 v18, v12, v17
  v_fma_f32 v19, -v18, v16, v12
  v_fma_f32 v19, v19, v17, v18
  v_cmp_class_f32 vcc, v19, 3
  s_nop 1
  v_cndmask_b32 v12, v19, v18, vcc
  v_cvt_pk_bf16_f32 v13, v13, v13
  v_and_b32 v13, 0xffff0000, v13
  v_mul_f32 v16, s35, v13
  v_exp_f32 v16, v16
  s_nop 0
  v_add_f32 v16, 1.0, v16
  v_rcp_f32 v17, v16
  s_nop 0
  v_mul_f32 v18, v13, v17
  v_fma_f32 v19, -v18, v16, v13
  v_fma_f32 v19, v19, v17, v18
  v_cmp_class_f32 vcc, v19, 3
  s_nop 1
  v_cndmask_b32 v13, v19, v18, vcc
  v_cvt_pk_bf16_f32 v14, v14, v14
  v_and_b32 v14, 0xffff0000, v14
  v_mul_f32 v16, s35, v14
  v_exp_f32 v16, v16
  s_nop 0
  v_add_f32 v16, 1.0, v16
  v_rcp_f32 v17, v16
  s_nop 0
  v_mul_f32 v18, v14, v17
  v_fma_f32 v19, -v18, v16, v14
  v_fma_f32 v19, v19, v17, v18
  v_cmp_class_f32 vcc, v19, 3
  s_nop 1
  v_cndmask_b32 v14, v19, v18, vcc
  v_cvt_pk_bf16_f32 v15, v15, v15
  v_and_b32 v15, 0xffff0000, v15
  v_mul_f32 v16, s35, v15
  v_exp_f32 v16, v16
  s_nop 0
  v_add_f32 v16, 1.0, v16
  v_rcp_f32 v17, v16
  s_nop 0
  v_mul_f32 v18, v15, v17
  v_fma_f32 v19, -v18, v16, v15
  v_fma_f32 v19, v19, v17, v18
  v_cmp_class_f32 vcc, v19, 3
  s_nop 1
  v_cndmask_b32 v15, v19, v18, vcc
  v_cvt_pk_bf16_f32 v8, v8, v9
  v_cvt_pk_bf16_f32 v9, v10, v11
  v_cvt_pk_bf16_f32 v10, v12, v13
  v_cvt_pk_bf16_f32 v11, v14, v15
  ds_write_b128 v3, v[8:11] offset:30720
  v_add_u32 v3, 256, v3
  s_add_u32 s76, s76, 1
  s_cmp_lt_u32 s76, 8
  s_cbranch_scc1 L_h_hfb2
L_h_hok:
  v_and_b32 v7, 7, v0
  v_lshlrev_b32 v4, 8, v7
  v_lshrrev_b32 v3, 4, v0
  v_lshl_add_u32 v4, v3, 4, v4
  v_bfe_u32 v5, v0, 2, 2
  v_lshlrev_b32 v5, 7, v5
  v_and_b32 v8, 3, v0
  v_lshl_add_u32 v5, v8, 3, v5
  v_lshl_add_u32 v5, v3, 10, v5
  v_add_u32 v5, s33, v5
  s_waitcnt vmcnt(0) lgkmcnt(0)
  ds_read_b128 v[8:11], v4 offset:30720
  ds_read_b128 v[12:15], v4 offset:30784
  ds_read_b128 v[16:19], v4 offset:30848
  ds_read_b128 v[20:23], v4 offset:30912
  ds_read_b64_tr_b16 v[40:41], v5 offset:0
  ds_read_b64_tr_b16 v[42:43], v5 offset:512
  ds_read_b64_tr_b16 v[44:45], v5 offset:4096
  ds_read_b64_tr_b16 v[46:47], v5 offset:4608
  ds_read_b64_tr_b16 v[48:49], v5 offset:8192
  ds_read_b64_tr_b16 v[50:51], v5 offset:8704
  ds_read_b64_tr_b16 v[52:53], v5 offset:12288
  ds_read_b64_tr_b16 v[54:55], v5 offset:12800
  s_waitcnt lgkmcnt(0)
  v_mfma_f32_16x16x32_bf16 v[24:27], v[40:43], v[8:11], 0
  v_mfma_f32_16x16x32_bf16 v[24:27], v[44:47], v[12:15], v[24:27]
  v_mfma_f32_16x16x32_bf16 v[24:27], v[48:51], v[16:19], v[24:27]
  v_mfma_f32_16x16x32_bf16 v[24:27], v[52:55], v[20:23], v[24:27]
  s_nop 7
  ds_read_b64_tr_b16 v[40:41], v5 offset:32
  ds_read_b64_tr_b16 v[42:43], v5 offset:544
  ds_read_b64_tr_b16 v[44:45], v5 offset:4128
  ds_read_b64_tr_b16 v[46:47], v5 offset:4640
  ds_read_b64_tr_b16 v[48:49], v5 offset:8224
  ds_read_b64_tr_b16 v[50:51], v5 offset:8736
  ds_read_b64_tr_b16 v[52:53], v5 offset:12320
  ds_read_b64_tr_b16 v[54:55], v5 offset:12832
  s_waitcnt lgkmcnt(0)
  v_mfma_f32_16x16x32_bf16 v[28:31], v[40:43], v[8:11], 0
  v_mfma_f32_16x16x32_bf16 v[28:31], v[44:47], v[12:15], v[28:31]
  v_mfma_f32_16x16x32_bf16 v[28:31], v[48:51], v[16:19], v[28:31]
  v_mfma_f32_16x16x32_bf16 v[28:31], v[52:55], v[20:23], v[28:31]
  s_nop 7
  ds_read_b64_tr_b16 v[40:41], v5 offset:64
  ds_read_b64_tr_b16 v[42:43], v5 offset:576
  ds_read_b64_tr_b16 v[44:45], v5 offset:4160
  ds_read_b64_tr_b16 v[46:47], v5 offset:4672
  ds_read_b64_tr_b16 v[48:49], v5 offset:8256
  ds_read_b64_tr_b16 v[50:51], v5 offset:8768
  ds_read_b64_tr_b16 v[52:53], v5 offset:12352
  ds_read_b64_tr_b16 v[54:55], v5 offset:12864
  s_waitcnt lgkmcnt(0)
  v_mfma_f32_16x16x32_bf16 v[32:35], v[40:43], v[8:11], 0
  v_mfma_f32_16x16x32_bf16 v[32:35], v[44:47], v[12:15], v[32:35]
  v_mfma_f32_16x16x32_bf16 v[32:35], v[48:51], v[16:19], v[32:35]
  v_mfma_f32_16x16x32_bf16 v[32:35], v[52:55], v[20:23], v[32:35]
  s_nop 7
  ds_read_b64_tr_b16 v[40:41], v5 offset:96
  ds_read_b64_tr_b16 v[42:43], v5 offset:608
  ds_read_b64_tr_b16 v[44:45], v5 offset:4192
  ds_read_b64_tr_b16 v[46:47], v5 offset:4704
  ds_read_b64_tr_b16 v[48:49], v5 offset:8288
  ds_read_b64_tr_b16 v[50:51], v5 offset:8800
  ds_read_b64_tr_b16 v[52:53], v5 offset:12384
  ds_read_b64_tr_b16 v[54:55], v5 offset:12896
  s_waitcnt lgkmcnt(0)
  v_mfma_f32_16x16x32_bf16 v[36:39], v[40:43], v[8:11], 0
  v_mfma_f32_16x16x32_bf16 v[36:39], v[44:47], v[12:15], v[36:39]
  v_mfma_f32_16x16x32_bf16 v[36:39], v[48:51], v[16:19], v[36:39]
  v_mfma_f32_16x16x32_bf16 v[36:39], v[52:55], v[20:23], v[36:39]
  s_nop 7
  v_mul_u32_u24 v7, 25088, v7
  v_lshl_add_u32 v7, v3, 4, v7
  v_bfe_u32 v3, v0, 3, 1
  v_lshl_add_u32 v7, v3, 6, v7
  s_mul_i32 s35, s68, 1792
  s_lshl_b32 s36, s78, 8
  s_add_u32 s35, s35, s36
  s_add_u32 s35, s35, 65536
  s_mov_b32 s42, 0xff00ff00
  s_mov_b32 s43, 0xff00ff00
  v_cndmask_b32 v40, v24, v28, s[42:43]
  v_cndmask_b32 v41, v25, v29, s[42:43]
  v_cndmask_b32 v42, v26, v30, s[42:43]
  v_cndmask_b32 v43, v27, v31, s[42:43]
  buffer_store_dwordx4 v[40:43], v7, s[52:55], s35 offen offset:0 sc1
  v_cndmask_b32 v44, v32, v36, s[42:43]
  v_cndmask_b32 v45, v33, v37, s[42:43]
  v_cndmask_b32 v46, v34, v38, s[42:43]
  v_cndmask_b32 v47, v35, v39, s[42:43]
  buffer_store_dwordx4 v[44:47], v7, s[52:55], s35 offen offset:128 sc1
  s_waitcnt vmcnt(0)
  s_mov_b64 exec, 1
  global_atomic_add v61, v62, s[22:23] offset:4
  s_mov_b64 exec, -1
L_h_f2done:
  s_cmp_lg_u32 s29, 2
  s_cbranch_scc1 L_h_nowarm
  s_mov_b64 exec, 0
  s_mov_b64 vcc, 0
  s_branch L_hop_0
L_h_warmed:
  s_mov_b64 exec, -1
L_h_nowarm:
L_poll_7:
  ds_read_b32 v3, v61 offset:12
  s_waitcnt lgkmcnt(0)
  v_readfirstlane_b32 s36, v3
  s_cmp_eq_u32 s36, 4
  s_cbranch_scc1 L_pd_8
  s_sleep 1
  s_branch L_poll_7
L_pd_8:
  ds_read_b128 v[8:11], v61 offset:64
  ds_read_b128 v[12:15], v61 offset:80
  ds_read_b32 v3, v61 offset:28
  s_waitcnt lgkmcnt(0)
  v_readfirstlane_b32 s70, v3
  v_max_f32 v16, v8, v10
  v_max3_f32 v16, v16, v12, v14
  s_mov_b32 s35, 0x3db8aa3b
  v_sub_f32 v8, v8, v16
  v_mul_f32 v8, s35, v8
  v_exp_f32 v8, v8
  v_sub_f32 v10, v10, v16
  v_mul_f32 v10, s35, v10
  v_exp_f32 v10, v10
  v_sub_f32 v12, v12, v16
  v_mul_f32 v12, s35, v12
  v_exp_f32 v12, v12
  v_sub_f32 v14, v14, v16
  v_mul_f32 v14, s35, v14
  v_exp_f32 v14, v14
  v_mul_f32 v17, v8, v9
  v_fmac_f32 v17, v10, v11
  v_fmac_f32 v17, v12, v13
  v_fmac_f32 v17, v14, v15
  s_cmp_lg_u32 s29, 0
  s_cbranch_scc1 L_h_nost
  s_lshl_b32 s35, s27, 9
  s_lshl_b32 s36, s30, 4
  s_add_u32 s35, s35, s36
  s_add_u32 s35, s35, 0
  v_mov_b32 v18, s70
  s_xor_b32 s36, s70, 1540483477
  v_mov_b32 v19, s36
  s_mov_b64 exec, 1
  buffer_store_dwordx4 v[16:19], v61, s[52:55], s35 offen sc1
  s_mov_b64 exec, -1
L_h_nost:
  s_mov_b32 s40, 0xffff0000
  s_mov_b32 s41, 0xffff0000
  s_waitcnt vmcnt(0)
  v_cndmask_b32 v18, v8, v12, s[40:41]
  v_cndmask_b32 v19, v10, v14, s[40:41]
  s_mov_b64 exec, 1
  ds_add_u32 v61, v62 offset:16
  s_mov_b64 exec, -1
  v_and_b32 v4, 7, v0
  v_mul_u32_u24 v4, 528, v4
  v_lshrrev_b32 v5, 4, v0
  v_lshl_add_u32 v4, v5, 4, v4
  v_lshlrev_b32 v7, 4, v0
  v_and_b32 v5, 7, v0
  v_lshlrev_b32 v5, 4, v5
  s_lshl_b32 s35, s27, 2
  s_add_u32 s35, s35, s29
  s_lshl_b32 s35, s35, 5
  s_add_u32 s35, s35, s30
  s_lshl_b32 s35, s35, 10
  s_add_u32 s34, s35, 3145728
  s_lshl_b32 s80, s27, 17
  s_lshl_b32 s35, s29, 13
  s_add_u32 s80, s80, s35
  s_add_u32 s80, s80, 3145728
  s_mul_i32 s82, s27, 25088
  s_mul_i32 s35, s29, 1792
  s_add_u32 s82, s82, s35
  s_add_u32 s82, s82, 65536
  s_lshl_b32 s60, s27, 9
  s_lshl_b32 s35, s29, 7
  s_add_u32 s60, s60, s35
  s_add_u32 s60, s60, 0
  s_mul_i32 s79, s27, 896
  s_mov_b32 s62, 0xff
  v_lshlrev_b32 v60, 1, v0
  v_cmp_gt_u32 vcc, 48, v0
  s_nop 1
  v_cndmask_b32 v1, v2, v60, vcc
  s_mov_b32 s42, 0
  s_mov_b32 s43, -1
  s_mov_b32 s48, s20
  s_mov_b32 s49, s21
  s_mov_b32 s50, 7168
  s_mov_b32 s51, 0x20000
  s_cmp_lg_u32 s29, 3
  s_cbranch_scc1 L_h_notk
L_poll_9:
  ds_read_b32 v3, v61 offset:16
  s_waitcnt lgkmcnt(0)
  v_readfirstlane_b32 s36, v3
  s_cmp_eq_u32 s36, 4
  s_cbranch_scc1 L_pd_10
  s_sleep 1
  s_branch L_poll_9
L_pd_10:
L_poll_11:
  ds_read_b32 v3, v61 offset:8
  s_waitcnt lgkmcnt(0)
  v_readfirstlane_b32 s36, v3
  s_cmp_eq_u32 s36, 4
  s_cbranch_scc1 L_pd_12
  s_sleep 8
  s_branch L_poll_11
L_pd_12:
  s_lshl_b32 s35, s27, 5
  v_mov_b32 v16, 4
  v_writelane_b32 v16, s35, 0
  v_mov_b32 v3, 0
  v_writelane_b32 v3, 1, 0
  s_mov_b64 exec, 3
  global_atomic_add v17, v16, v3, s[22:23] offset:0 sc0
  s_mov_b64 exec, -1
L_h_notk:
  s_waitcnt lgkmcnt(0)
  s_barrier
L_hop_0:
  s_cbranch_execz L_hop_1
  ds_read_b128 v[20:23], v4 offset:8192
  ds_read_b128 v[24:27], v4 offset:8256
  ds_read_b128 v[28:31], v4 offset:8320
  ds_read_b128 v[32:35], v4 offset:8384
  ds_read_b128 v[36:39], v4 offset:8448
  ds_read_b128 v[40:43], v4 offset:8512
L_hop_1:
  s_cbranch_execz L_hop_2
  ds_read_b128 v[44:47], v4 offset:8576
  ds_read_b128 v[48:51], v4 offset:8640
  s_waitcnt lgkmcnt(7)
  v_mfma_f32_16x16x32_bf16 v[52:55], v[20:23], v[64:67], 0
  v_mfma_f32_16x16x32_bf16 v[56:59], v[20:23], v[96:99], 0
  v_mfma_f32_16x16x32_bf16 v[8:11], v[20:23], v[128:131], 0
  v_mfma_f32_16x16x32_bf16 v[12:15], v[20:23], v[160:163], 0
L_hop_2:
  s_cbranch_execz L_hop_3
  s_waitcnt lgkmcnt(6)
  v_mfma_f32_16x16x32_bf16 v[52:55], v[24:27], v[68:71], v[52:55]
  v_mfma_f32_16x16x32_bf16 v[56:59], v[24:27], v[100:103], v[56:59]
  ds_read_b128 v[64:67], v6 offset:0
  v_mfma_f32_16x16x32_bf16 v[8:11], v[24:27], v[132:135], v[8:11]
  v_mfma_f32_16x16x32_bf16 v[12:15], v[24:27], v[164:167], v[12:15]
  s_waitcnt lgkmcnt(6)
L_hop_3:
  s_cbranch_execz L_hop_4
  v_mfma_f32_16x16x32_bf16 v[52:55], v[28:31], v[72:75], v[52:55]
  v_mfma_f32_16x16x32_bf16 v[56:59], v[28:31], v[104:107], v[56:59]
  ds_read_b128 v[68:71], v6 offset:1024
  v_mfma_f32_16x16x32_bf16 v[8:11], v[28:31], v[136:139], v[8:11]
  v_mfma_f32_16x16x32_bf16 v[12:15], v[28:31], v[168:171], v[12:15]
  s_waitcnt lgkmcnt(6)
  v_mfma_f32_16x16x32_bf16 v[52:55], v[32:35], v[76:79], v[52:55]
L_hop_4:
  s_cbranch_execz L_hop_5
  v_mfma_f32_16x16x32_bf16 v[56:59], v[32:35], v[108:111], v[56:59]
  ds_read_b128 v[72:75], v6 offset:2048
  v_mfma_f32_16x16x32_bf16 v[8:11], v[32:35], v[140:143], v[8:11]
  v_mfma_f32_16x16x32_bf16 v[12:15], v[32:35], v[172:175], v[12:15]
  s_waitcnt lgkmcnt(6)
  v_mfma_f32_16x16x32_bf16 v[52:55], v[36:39], v[80:83], v[52:55]
  v_mfma_f32_16x16x32_bf16 v[56:59], v[36:39], v[112:115], v[56:59]
L_hop_5:
  s_cbranch_execz L_hop_6
  ds_read_b128 v[76:79], v6 offset:3072
  v_mfma_f32_16x16x32_bf16 v[8:11], v[36:39], v[144:147], v[8:11]
  v_mfma_f32_16x16x32_bf16 v[12:15], v[36:39], v[176:179], v[12:15]
  s_waitcnt lgkmcnt(6)
  v_mfma_f32_16x16x32_bf16 v[52:55], v[40:43], v[84:87], v[52:55]
  v_mfma_f32_16x16x32_bf16 v[56:59], v[40:43], v[116:119], v[56:59]
  ds_read_b128 v[80:83], v6 offset:4096
L_hop_6:
  s_cbranch_execz L_hop_7
  v_mfma_f32_16x16x32_bf16 v[8:11], v[40:43], v[148:151], v[8:11]
  v_mfma_f32_16x16x32_bf16 v[12:15], v[40:43], v[180:183], v[12:15]
  s_waitcnt lgkmcnt(6)
  v_mfma_f32_16x16x32_bf16 v[52:55], v[44:47], v[88:91], v[52:55]
  v_mfma_f32_16x16x32_bf16 v[56:59], v[44:47], v[120:123], v[56:59]
  ds_read_b128 v[84:87], v6 offset:5120
  v_mfma_f32_16x16x32_bf16 v[8:11], v[44:47], v[152:155], v[8:11]
L_hop_7:
  s_cbranch_execz L_hop_8
  v_mfma_f32_16x16x32_bf16 v[12:15], v[44:47], v[184:187], v[12:15]
  s_waitcnt lgkmcnt(6)
  v_mfma_f32_16x16x32_bf16 v[52:55], v[48:51], v[92:95], v[52:55]
  v_mfma_f32_16x16x32_bf16 v[56:59], v[48:51], v[124:127], v[56:59]
  ds_read_b128 v[88:91], v6 offset:6144
  v_mfma_f32_16x16x32_bf16 v[8:11], v[48:51], v[156:159], v[8:11]
  v_mfma_f32_16x16x32_bf16 v[12:15], v[48:51], v[188:191], v[12:15]
L_hop_8:
  s_cbranch_execz L_hop_9
  ds_read_b128 v[92:95], v6 offset:7168
  v_mfma_f32_16x16x32_bf16 v[96:99], v[20:23], v[192:195], 0
  v_mfma_f32_16x16x32_bf16 v[100:103], v[20:23], v[224:227], 0
  s_waitcnt lgkmcnt(7)
  v_mfma_f32_16x16x32_bf16 v[104:107], v[20:23], v[64:67], 0
  v_mfma_f32_16x16x32_bf16 v[96:99], v[24:27], v[196:199], v[96:99]
  v_mfma_f32_16x16x32_bf16 v[100:103], v[24:27], v[228:231], v[100:103]
L_hop_9:
  s_cbranch_execz L_hop_10
  s_waitcnt lgkmcnt(6)
  v_mfma_f32_16x16x32_bf16 v[104:107], v[24:27], v[68:71], v[104:107]
  v_mfma_f32_16x16x32_bf16 v[96:99], v[28:31], v[200:203], v[96:99]
  v_mfma_f32_16x16x32_bf16 v[100:103], v[28:31], v[232:235], v[100:103]
  s_waitcnt lgkmcnt(5)
  v_mfma_f32_16x16x32_bf16 v[104:107], v[28:31], v[72:75], v[104:107]
  v_mfma_f32_16x16x32_bf16 v[96:99], v[32:35], v[204:207], v[96:99]
L_hop_10:
  s_cbranch_execz L_hop_11
  v_mfma_f32_16x16x32_bf16 v[100:103], v[32:35], v[236:239], v[100:103]
  s_waitcnt lgkmcnt(4)
  v_mfma_f32_16x16x32_bf16 v[104:107], v[32:35], v[76:79], v[104:107]
  v_mfma_f32_16x16x32_bf16 v[96:99], v[36:39], v[208:211], v[96:99]
  v_mfma_f32_16x16x32_bf16 v[100:103], v[36:39], v[240:243], v[100:103]
  s_waitcnt lgkmcnt(3)
  v_mfma_f32_16x16x32_bf16 v[104:107], v[36:39], v[80:83], v[104:107]
L_hop_11:
  s_cbranch_execz L_hop_12
  v_mfma_f32_16x16x32_bf16 v[96:99], v[40:43], v[212:215], v[96:99]
  v_mfma_f32_16x16x32_bf16 v[100:103], v[40:43], v[244:247], v[100:103]
  s_waitcnt lgkmcnt(2)
  v_mfma_f32_16x16x32_bf16 v[104:107], v[40:43], v[84:87], v[104:107]
  v_mfma_f32_16x16x32_bf16 v[96:99], v[44:47], v[216:219], v[96:99]
  v_mfma_f32_16x16x32_bf16 v[100:103], v[44:47], v[248:251], v[100:103]
  s_waitcnt lgkmcnt(1)
L_hop_12:
  s_cbranch_execz L_hop_13
  v_mfma_f32_16x16x32_bf16 v[104:107], v[44:47], v[88:91], v[104:107]
  v_mfma_f32_16x16x32_bf16 v[96:99], v[48:51], v[220:223], v[96:99]
  v_mfma_f32_16x16x32_bf16 v[100:103], v[48:51], v[252:255], v[100:103]
  s_waitcnt lgkmcnt(0)
  v_mfma_f32_16x16x32_bf16 v[104:107], v[48:51], v[92:95], v[104:107]
  v_add_f32 v52, v52, v53
  v_add_f32 v54, v54, v55
  v_mul_f32 v112, v18, v52
L_hop_13:
  s_cbranch_execz L_hop_14
  v_fmac_f32 v112, v19, v54
  v_add_f32 v56, v56, v57
  v_add_f32 v58, v58, v59
  v_mul_f32 v113, v18, v56
  v_fmac_f32 v113, v19, v58
  v_add_f32 v8, v8, v9
  v_add_f32 v10, v10, v11
  v_mul_f32 v114, v18, v8
  v_fmac_f32 v114, v19, v10
  v_add_f32 v12, v12, v13
L_hop_14:
  s_cbranch_execz L_hop_15
  v_add_f32 v14, v14, v15
  v_mul_f32 v115, v18, v12
  v_fmac_f32 v115, v19, v14
  v_add_f32 v96, v96, v97
  v_add_f32 v98, v98, v99
  v_mul_f32 v116, v18, v96
  v_fmac_f32 v116, v19, v98
  v_add_f32 v100, v100, v101
  v_add_f32 v102, v102, v103
  v_mul_f32 v117, v18, v100
L_hop_15:
  s_cbranch_execz L_hop_16
  v_fmac_f32 v117, v19, v102
  v_add_f32 v104, v104, v105
  v_add_f32 v106, v106, v107
  v_mul_f32 v118, v18, v104
  v_fmac_f32 v118, v19, v106
  v_mov_b32 v119, v118
  v_permlane16_swap_b32 v112, v113
  v_permlane16_swap_b32 v114, v115
L_hop_16:
  s_cbranch_execz L_hop_17
  v_permlane16_swap_b32 v116, v117
  v_permlane16_swap_b32 v118, v119
  v_add_f32 v112, v112, v113
  v_add_f32 v114, v114, v115
  v_add_f32 v116, v116, v117
  v_add_f32 v118, v118, v119
  v_cndmask_b32 v8, v112, v114, s[42:43]
  v_cndmask_b32 v10, v116, v118, s[42:43]
  v_mov_b32 v9, s70
L_hop_17:
  s_cbranch_execz L_hop_18
  v_mov_b32 v11, s70
  s_waitcnt vmcnt(0)
  buffer_store_dwordx4 v[8:11], v7, s[52:55], s34 offen sc1
  s_cmp_lg_u32 s29, 3
  s_cbranch_scc1 L_h_waitv
  v_readlane_b32 s36, v17, 0
  s_sub_u32 s37, s36, 28
  s_cmp_lt_u32 s37, 4
  s_cbranch_scc1 L_h_tk1
L_hop_18:
  s_cbranch_execz L_hop_19
  ds_write_b32 v61, v62 offset:20
  s_branch L_h_fin
L_h_tk1:
  s_add_u32 s35, s36, 1
  s_sub_u32 s36, s36, 26
L_h_tk2:
  v_readlane_b32 s37, v17, 1
  s_cmp_ge_u32 s37, 98
  s_cselect_b32 s35, s35, 0
  s_cmp_ge_u32 s35, 1
L_hop_19:
  s_cbranch_execz L_hop_20
  s_cbranch_scc1 L_h_tk3
  s_mov_b64 exec, 3
  global_atomic_add v17, v16, v61, s[22:23] offset:0 sc0
  s_mov_b64 exec, -1
  s_waitcnt vmcnt(0)
  v_readlane_b32 s35, v17, 0
  s_branch L_h_tk2
L_h_tk3:
  v_mov_b32 v3, s36
L_hop_20:
  s_cbranch_execz L_hop_21
  ds_write_b32 v61, v3 offset:20
  s_branch L_h_gotv
L_h_waitv:
  ds_read_b32 v3, v61 offset:20
  s_waitcnt lgkmcnt(0)
  v_readfirstlane_b32 s36, v3
  s_cmp_eq_u32 s36, 0
  s_cbranch_scc1 L_h_waitv
  s_cmp_lt_u32 s36, 2
  s_cbranch_scc1 L_h_fin
L_h_gotv:
L_hop_21:
  s_cbranch_execz L_hop_22
  s_sub_u32 s36, s36, 2
  s_lshl_b32 s35, s36, 15
  s_add_u32 s80, s80, s35
  s_add_u32 s81, s80, 4096
  s_mul_i32 s35, s36, 448
  s_add_u32 s82, s82, s35
L_hop_22:
  s_cbranch_execz L_hop_23
  s_add_u32 s83, s82, 7168
  s_add_u32 s84, s82, 14336
  s_add_u32 s85, s82, 21504
  s_mul_i32 s35, s36, 224
  s_add_u32 s79, s79, s35
  buffer_load_dwordx4 v[20:23], v5, s[52:55], s60 offen sc1
L_hop_23:
  s_cbranch_execz L_hop_24
  v_lshlrev_b32 v6, 2, v0
  s_cmp_ge_u32 s29, 2
  s_cselect_b64 vcc, -1, 0
  v_cndmask_b32 v3, v6, v2, vcc
  buffer_load_dword v96, v6, s[52:55], s82 offen sc1
  buffer_load_dword v97, v6, s[52:55], s82 offen offset:256 sc1
  buffer_load_dword v98, v6, s[52:55], s83 offen sc1
L_hop_24:
  s_cbranch_execz L_hop_25
  buffer_load_dword v99, v6, s[52:55], s83 offen offset:256 sc1
  buffer_load_dword v100, v6, s[52:55], s84 offen sc1
  buffer_load_dword v101, v6, s[52:55], s84 offen offset:256 sc1
  buffer_load_dword v102, v3, s[52:55], s85 offen sc1
  buffer_load_dword v103, v3, s[52:55], s85 offen offset:256 sc1
  buffer_load_ushort v24, v60, s[44:47], s79 offen nt
L_hop_25:
  s_cbranch_execz L_hop_26
  buffer_load_ushort v25, v1, s[44:47], s79 offen offset:128 nt
  s_mov_b32 s63, 1
L_h_round:
  s_mov_b64 vcc, -1
  s_bitcmp1_b32 s62, 7
  s_cselect_b64 exec, -1, 0
  buffer_load_dwordx4 v[64:67], v7, s[52:55], s80 offen offset:0 sc1
  s_bitcmp1_b32 s62, 6
  s_cselect_b64 exec, -1, 0
L_hop_26:
  s_cbranch_vccz L_hop_27
  buffer_load_dwordx4 v[68:71], v7, s[52:55], s80 offen offset:1024 sc1
  s_bitcmp1_b32 s62, 5
  s_cselect_b64 exec, -1, 0
  buffer_load_dwordx4 v[72:75], v7, s[52:55], s80 offen offset:2048 sc1
  s_bitcmp1_b32 s62, 4
  s_cselect_b64 exec, -1, 0
  buffer_load_dwordx4 v[76:79], v7, s[52:55], s80 offen offset:3072 sc1
  s_bitcmp1_b32 s62, 3
  s_cselect_b64 exec, -1, 0
L_hop_27:
  s_cbranch_vccz L_hop_28
  buffer_load_dwordx4 v[80:83], v7, s[52:55], s81 offen offset:0 sc1
  s_bitcmp1_b32 s62, 2
  s_cselect_b64 exec, -1, 0
  buffer_load_dwordx4 v[84:87], v7, s[52:55], s81 offen offset:1024 sc1
  s_bitcmp1_b32 s62, 1
  s_cselect_b64 exec, -1, 0
  buffer_load_dwordx4 v[88:91], v7, s[52:55], s81 offen offset:2048 sc1
  s_bitcmp1_b32 s62, 0
  s_cselect_b64 exec, -1, 0
L_hop_28:
  s_cbranch_vccz L_hop_29
  buffer_load_dwordx4 v[92:95], v7, s[52:55], s81 offen offset:3072 sc1
  s_mov_b64 exec, -1
  s_cmp_eq_u32 s63, 0
  s_cbranch_scc1 L_h_r2
  s_mov_b32 s63, 0
  s_waitcnt vmcnt(18)
  s_sub_u32 s72, s70, 1000
  s_mov_b32 s74, 7000
L_hop_29:
  s_cbranch_execz L_hop_30
  s_mov_b32 s75, 1540483477
  v_subrev_u32 v12, s72, v22
  v_xor_b32 v13, v22, v23
  v_cmp_le_u32 vcc, s74, v12
  v_cmp_ne_u32 s[40:41], s75, v13
  s_nop 1
L_hop_30:
  s_cbranch_execz L_hop_31
  s_or_b64 vcc, vcc, s[40:41]
  s_cmp_eq_u64 vcc, 0
  s_cbranch_scc1 L_h_stok
  s_lshl_b32 s35, s27, 5
  v_mov_b32 v12, s35
L_h_stw:
  s_mov_b64 exec, 1
  global_atomic_add v13, v12, v61, s[22:23] offset:0 sc0
  s_mov_b64 exec, -1
L_hop_31:
  s_cbranch_execz L_hop_32
  s_waitcnt vmcnt(0)
  v_readfirstlane_b32 s35, v13
  s_cmp_lt_u32 s35, 32
  s_cbranch_scc1 L_h_stw
  buffer_load_dwordx4 v[20:23], v5, s[52:55], s60 offen sc1
  s_waitcnt vmcnt(0)
L_h_stok:
  s_mov_b32 s36, 0x3db8aa3b
  v_mov_b32_dpp v12, v20 quad_perm:[1,0,3,2] row_mask:0xf bank_mask:0xf
L_hop_32:
  s_cbranch_execz L_hop_33
  v_mov_b32_dpp v13, v21 quad_perm:[1,0,3,2] row_mask:0xf bank_mask:0xf
  v_max_f32 v14, v20, v12
  v_sub_f32 v20, v20, v14
  v_sub_f32 v12, v12, v14
  v_mul_f32 v20, s36, v20
  v_mul_f32 v12, s36, v12
  v_exp_f32 v20, v20
  v_exp_f32 v12, v12
  v_mul_f32 v14, v20, v21
  v_mul_f32 v13, v12, v13
  v_add_f32 v14, v14, v13
L_hop_33:
  s_cbranch_execz L_hop_34
  v_rcp_f32 v15, v14
  s_nop 0
  v_mul_f32 v12, v20, v15
  v_fma_f32 v13, -v12, v14, v20
  v_fma_f32 v20, v13, v15, v12
  s_waitcnt vmcnt(10)
  v_add_f32 v14, v96, v98
  v_add_f32 v15, v97, v99
  v_add_f32 v14, v14, v100
  v_add_f32 v15, v15, v101
L_hop_34:
  s_cbranch_execz L_hop_35
  v_add_f32 v14, v14, v102
  v_add_f32 v15, v15, v103
L_h_r2:
  v_mov_b32 v12, 0
  v_mov_b32 v13, 0
  v_mov_b32 v16, 0
  s_mov_b32 s37, 0x0c0c0400
  s_waitcnt vmcnt(7)
  v_xor_b32_dpp v17, v22, v65 row_newbcast:0 row_mask:0xf bank_mask:0xf
  v_bitop3_b32 v17, v17, v65, v67 bitop3:0xf6
L_hop_35:
  s_cbranch_execz L_hop_36
  v_cmp_ne_u32 vcc, 0, v17
  v_fmac_f32_dpp v12, v20, v64 row_newbcast:0 row_mask:0xf bank_mask:0xf
  v_fmac_f32_dpp v13, v20, v66 row_newbcast:0 row_mask:0xf bank_mask:0xf
  v_addc_co_u32 v16, vcc, v16, v16, vcc
  s_waitcnt vmcnt(6)
  v_xor_b32_dpp v17, v22, v69 row_newbcast:1 row_mask:0xf bank_mask:0xf
  v_bitop3_b32 v17, v17, v69, v71 bitop3:0xf6
L_hop_36:
  s_cbranch_execz L_hop_37
  v_cmp_ne_u32 vcc, 0, v17
  v_fmac_f32_dpp v12, v20, v68 row_newbcast:1 row_mask:0xf bank_mask:0xf
  v_fmac_f32_dpp v13, v20, v70 row_newbcast:1 row_mask:0xf bank_mask:0xf
  v_addc_co_u32 v16, vcc, v16, v16, vcc
  s_waitcnt vmcnt(5)
  v_xor_b32_dpp v17, v22, v73 row_newbcast:2 row_mask:0xf bank_mask:0xf
  v_bitop3_b32 v17, v17, v73, v75 bitop3:0xf6
L_hop_37:
  s_cbranch_execz L_hop_38
  v_cmp_ne_u32 vcc, 0, v17
  v_fmac_f32_dpp v12, v20, v72 row_newbcast:2 row_mask:0xf bank_mask:0xf
  v_fmac_f32_dpp v13, v20, v74 row_newbcast:2 row_mask:0xf bank_mask:0xf
  v_addc_co_u32 v16, vcc, v16, v16, vcc
  s_waitcnt vmcnt(4)
  v_xor_b32_dpp v17, v22, v77 row_newbcast:3 row_mask:0xf bank_mask:0xf
  v_bitop3_b32 v17, v17, v77, v79 bitop3:0xf6
L_hop_38:
  s_cbranch_execz L_hop_39
  v_cmp_ne_u32 vcc, 0, v17
  v_fmac_f32_dpp v12, v20, v76 row_newbcast:3 row_mask:0xf bank_mask:0xf
  v_fmac_f32_dpp v13, v20, v78 row_newbcast:3 row_mask:0xf bank_mask:0xf
  v_addc_co_u32 v16, vcc, v16, v16, vcc
  s_waitcnt vmcnt(3)
  v_xor_b32_dpp v17, v22, v81 row_newbcast:4 row_mask:0xf bank_mask:0xf
  v_bitop3_b32 v17, v17, v81, v83 bitop3:0xf6
L_hop_39:
  s_cbranch_execz L_hop_40
  v_cmp_ne_u32 vcc, 0, v17
  v_fmac_f32_dpp v12, v20, v80 row_newbcast:4 row_mask:0xf bank_mask:0xf
  v_fmac_f32_dpp v13, v20, v82 row_newbcast:4 row_mask:0xf bank_mask:0xf
  v_addc_co_u32 v16, vcc, v16, v16, vcc
  s_waitcnt vmcnt(2)
  v_xor_b32_dpp v17, v22, v85 row_newbcast:5 row_mask:0xf bank_mask:0xf
  v_bitop3_b32 v17, v17, v85, v87 bitop3:0xf6
L_hop_40:
  s_cbranch_execz L_hop_41
  v_cmp_ne_u32 vcc, 0, v17
  v_fmac_f32_dpp v12, v20, v84 row_newbcast:5 row_mask:0xf bank_mask:0xf
  v_fmac_f32_dpp v13, v20, v86 row_newbcast:5 row_mask:0xf bank_mask:0xf
  v_addc_co_u32 v16, vcc, v16, v16, vcc
  s_waitcnt vmcnt(1)
  v_xor_b32_dpp v17, v22, v89 row_newbcast:6 row_mask:0xf bank_mask:0xf
  v_bitop3_b32 v17, v17, v89, v91 bitop3:0xf6
L_hop_41:
  s_cbranch_execz L_hop_42
  v_cmp_ne_u32 vcc, 0, v17
  v_fmac_f32_dpp v12, v20, v88 row_newbcast:6 row_mask:0xf bank_mask:0xf
  v_fmac_f32_dpp v13, v20, v90 row_newbcast:6 row_mask:0xf bank_mask:0xf
  v_addc_co_u32 v16, vcc, v16, v16, vcc
  s_waitcnt vmcnt(0)
  v_xor_b32_dpp v17, v22, v93 row_newbcast:7 row_mask:0xf bank_mask:0xf
  v_bitop3_b32 v17, v17, v93, v95 bitop3:0xf6
L_hop_42:
  s_cbranch_execz L_hop_43
  v_cmp_ne_u32 vcc, 0, v17
  v_fmac_f32_dpp v12, v20, v92 row_newbcast:7 row_mask:0xf bank_mask:0xf
  v_fmac_f32_dpp v13, v20, v94 row_newbcast:7 row_mask:0xf bank_mask:0xf
  v_addc_co_u32 v16, vcc, v16, v16, vcc
  v_cmp_ne_u32 vcc, 0, v16
  s_nop 1
  s_cmp_eq_u64 vcc, 0
  s_cbranch_scc1 L_h_all
L_hop_43:
  s_cbranch_execz L_hop_44
  v_or_b32_dpp v16, v16, v16 row_ror:8 row_mask:0xf bank_mask:0xf
  s_nop 1
  v_or_b32_dpp v16, v16, v16 row_ror:4 row_mask:0xf bank_mask:0xf
  s_nop 1
  v_or_b32_dpp v16, v16, v16 row_ror:2 row_mask:0xf bank_mask:0xf
  s_nop 1
  v_or_b32_dpp v16, v16, v16 row_ror:1 row_mask:0xf bank_mask:0xf
  v_mov_b32 v17, v16
L_hop_44:
  s_cbranch_execz L_hop_45
  s_nop 0
  v_permlane16_swap_b32 v16, v17
  v_or_b32 v16, v16, v17
  v_mov_b32 v17, v16
  s_nop 1
  v_permlane32_swap_b32 v16, v17
  v_or_b32 v16, v16, v17
  s_nop 0
  v_readfirstlane_b32 s62, v16
L_hop_45:
  s_cbranch_execz L_hop_46
  s_branch L_h_round
L_h_all:
  s_cmp_eq_u32 s29, 0
  s_cbranch_scc1 L_h_red
  v_add_u32 v3, s33, v7
  ds_write_b128 v3, v[12:15]
  s_waitcnt lgkmcnt(0)
  s_mov_b64 exec, 1
  ds_add_u32 v61, v62 offset:24
  s_mov_b64 exec, -1
L_hop_46:
  s_cbranch_execz L_hop_47
  s_branch L_h_fin
L_h_red:
  ds_read_b32 v3, v61 offset:24
  s_waitcnt lgkmcnt(0)
  v_readfirstlane_b32 s36, v3
  s_cmp_lg_u32 s36, 3
  s_cbranch_scc1 L_h_red
  v_add_u32 v3, 50176, v7
  ds_read_b128 v[28:31], v3
L_hop_47:
  s_cbranch_execz L_hop_48
  ds_read_b128 v[32:35], v3 offset:16384
  ds_read_b128 v[36:39], v3 offset:32768
  v_lshlrev_b32 v24, 16, v24
  v_lshlrev_b32 v25, 16, v25
  s_waitcnt lgkmcnt(0)
  v_add_f32 v12, v12, v28
  v_add_f32 v32, v32, v36
  v_add_f32 v13, v13, v29
  v_add_f32 v33, v33, v37
L_hop_48:
  s_cbranch_execz L_hop_49
  v_add_f32 v14, v14, v30
  v_add_f32 v34, v34, v38
  v_add_f32 v15, v15, v31
  v_add_f32 v35, v35, v39
  v_add_f32 v12, v12, v32
  v_add_f32 v13, v13, v33
  v_add_f32 v14, v14, v34
  v_add_f32 v15, v15, v35
  v_cvt_pk_bf16_f32 v12, v12, v12
  v_and_b32 v12, 0xffff0000, v12
L_hop_49:
  s_cbranch_execz L_hop_50
  v_cvt_pk_bf16_f32 v13, v13, v13
  v_and_b32 v13, 0xffff0000, v13
  v_cvt_pk_bf16_f32 v14, v14, v14
  v_and_b32 v14, 0xffff0000, v14
  v_cvt_pk_bf16_f32 v15, v15, v15
  v_and_b32 v15, 0xffff0000, v15
  v_add_f32 v12, v24, v12
L_hop_50:
  s_cbranch_execz L_hop_51
  v_add_f32 v13, v25, v13
  v_cvt_pk_bf16_f32 v12, v12, v12
  v_and_b32 v12, 0xffff0000, v12
  v_cvt_pk_bf16_f32 v13, v13, v13
  v_and_b32 v13, 0xffff0000, v13
  v_add_f32 v12, v12, v14
  v_add_f32 v13, v13, v15
  v_cvt_pk_bf16_f32 v12, v12, v13
L_hop_51:
  s_cbranch_execz L_hop_52
  buffer_store_short v12, v60, s[48:51], s79 offen
  buffer_store_short_d16_hi v12, v1, s[48:51], s79 offen offset:128
L_hop_52:
  s_cbranch_execz L_h_warmed
L_h_fin:
  s_waitcnt lgkmcnt(0)
L_end:
  s_endpgm
.section .rodata,"a"
.p2align 6
.amdhsa_kernel parallel_sum__mha_block_cached__dense_activation_silu__decode_kernel
  .amdhsa_next_free_vgpr 256
  .amdhsa_next_free_sgpr 102
  .amdhsa_accum_offset 256
  .amdhsa_float_denorm_mode_32 3
  .amdhsa_group_segment_fixed_size 0
  .amdhsa_kernarg_size 88
  .amdhsa_user_sgpr_count 2
  .amdhsa_user_sgpr_kernarg_segment_ptr 1
  .amdhsa_system_sgpr_workgroup_id_x 1
.end_amdhsa_kernel
```
